```python
import torch

def _softmax(x, axis=-1):
    return torch.softmax(x, dim=axis)
def _gelu(x):
    return torch.nn.functional.gelu(x, approximate="tanh")
def _silu(x):
    return torch.nn.functional.silu(x)
def _sigmoid(x):
    return torch.sigmoid(x)
def _layernorm(x, axis=-1, eps=1e-5):
    m = x.mean(dim=axis, keepdim=True)
    v = x.var(dim=axis, keepdim=True, unbiased=False)
    return (x - m) / torch.sqrt(v + eps)
def _scatter_add(tgt, idx, src, axis=0):
    return tgt.clone().index_add_(axis, idx, src)
def _segment_sum(src, seg, n):
    out = torch.zeros((n,) + src.shape[1:], dtype=src.dtype)
    return out.index_add_(0, seg, src)
def _pad(x, pw):
    flat = tuple(v for pair in reversed(pw) for v in pair)
    return torch.nn.functional.pad(x, flat)

kernel_name = 'gated_mix__softmax_full_mha__mha_block__prompt'

def setup_inputs():

    _w = (lambda a: (lambda t: t.to(torch.bfloat16) if t.is_floating_point() else t)(torch.as_tensor(a)))
    def _A_setup():
        B, S, D = 1, 2048, 512
        return {
            "x": _w((lambda *s: torch.randn(*s, dtype=torch.bfloat16) * 0.05)(B, S, D)),
            "wqkv": _w((lambda *s: torch.randn(*s, dtype=torch.bfloat16) * 0.8)(D, 3 * D)),
            "wo": _w((lambda *s: torch.randn(*s, dtype=torch.bfloat16) * 0.05)(D, D)),
        }
    _A_in = _A_setup()

    def _B_setup():
        B, S, D, H = 1, 2048, 512, 32
        return {
            "x": _w((lambda *s: torch.randn(*s, dtype=torch.bfloat16) * 0.05)(B, S, D)),
            "wqkv": _w((lambda *s: torch.randn(*s, dtype=torch.bfloat16) * 0.8)(D, 3 * D)),
            "wo": _w((lambda *s: torch.randn(*s, dtype=torch.bfloat16) * 0.05)(D, D)),
        }
    _B_in = _B_setup()

    return {
        "A_x": _A_in["x"],
        "A_wqkv": _A_in["wqkv"],
        "A_wo": _A_in["wo"],
        "B_x": _B_in["x"],
        "B_wqkv": _B_in["wqkv"],
        "B_wo": _B_in["wo"],
        "gate_w": _w((lambda *s: torch.randn(*s, dtype=torch.bfloat16) * 0.05)(512) * 16.0),
    }

def reference(A_x, A_wqkv, A_wo, B_x, B_wqkv, B_wo, gate_w):
    def _A_ref(x, wqkv, wo):
        B, S, D = x.shape
        H = 32; Dh = D // H
        qkv = (lambda x, *d: x.permute(*d))((x @ wqkv).reshape(B, S, 3, H, Dh), 2, 0, 3, 1, 4)
        q, k, v = qkv[0], qkv[1], qkv[2]
        scale = Dh ** -0.5
        scores = torch.einsum("bhqd,bhkd->bhqk", q, k) * scale
        p = _softmax(scores, axis=-1)
        o = torch.einsum("bhqk,bhkd->bhqd", p, v)
        return (lambda x, *d: x.permute(*d))(o, 0, 2, 1, 3).reshape(B, S, D) @ wo

    def _B_ref(x, wqkv, wo):
        B, S, D = x.shape
        H = 32
        Dh = D // H
        qkv = (lambda x, *d: x.permute(*d))((x @ wqkv).reshape(B, S, 3, H, Dh), 2, 0, 3, 1, 4)
        q, k, v = qkv[0], qkv[1], qkv[2]
        scores = torch.einsum("bhqd,bhkd->bhqk", q, k) * (Dh ** -0.5)
        p = _softmax(scores, axis=-1)
        o = torch.einsum("bhqk,bhkd->bhqd", p, v)
        return (lambda x, *d: x.permute(*d))(o, 0, 2, 1, 3).reshape(B, S, D) @ wo

    x = A_x
    g = _sigmoid((x * gate_w).sum(-1, keepdims=True))
    a = _A_ref(x, A_wqkv, A_wo)
    b = _B_ref(x, B_wqkv, B_wo)
    return g * a + (1 - g) * b
```

```asm
; @launch grid=(256,1,1) block=(512,1,1) lds=163840
.amdgcn_target "amdgcn-amd-amdhsa--gfx950"
.text
.globl gated_mix__softmax_full_mha__mha_block__prompt_kernel
.p2align 8
.type gated_mix__softmax_full_mha__mha_block__prompt_kernel,@function
gated_mix__softmax_full_mha__mha_block__prompt_kernel:
  s_cmp_ge_u32 s2, 256
  s_cbranch_scc1 L_end
  s_load_dwordx16 s[4:19], s[0:1], 0
  s_load_dwordx4 s[20:23], s[0:1], 64
  v_lshrrev_b32 v1, 6, v0
  v_and_b32 v0, 63, v0
  v_readfirstlane_b32 s56, v1
  s_and_b32 s62, s2, 1
  s_lshl_b32 s62, s62, 2
  s_lshr_b32 s63, s2, 3
  s_and_b32 s64, s63, 3
  s_or_b32 s57, s62, s64
  s_and_b32 s62, s2, 7
  s_lshr_b32 s62, s62, 1
  s_lshl_b32 s62, s62, 3
  s_lshr_b32 s63, s63, 2
  s_add_u32 s58, s62, s63
  s_and_b32 s60, s56, 3
  s_cmp_ge_u32 s56, 4
  s_cbranch_scc1 L_loader
  s_setprio 1
  s_waitcnt lgkmcnt(0)
  s_mov_b32 s24, s4
  s_mov_b32 s25, s5
  s_mov_b32 s26, 0x200000
  s_mov_b32 s27, 0x20000
  s_mov_b32 s32, s16
  s_mov_b32 s33, s17
  s_mov_b32 s34, 0x400
  s_mov_b32 s35, 0x20000
  s_lshl_b32 s68, s2, 2
  s_add_u32 s68, s68, s56
  s_lshl_b32 s69, s68, 11
  v_lshlrev_b32 v13, 4, v0
  buffer_load_dwordx4 v[32:35], v13, s[24:27], s69 offen
  buffer_load_dwordx4 v[36:39], v13, s[24:27], s69 offen offset:1024
  buffer_load_dwordx4 v[40:43], v13, s[32:35], 0 offen
  s_mov_b32 s36, s22
  s_mov_b32 s37, s23
  s_mov_b32 s38, 0x1800000
  s_mov_b32 s39, 0x20000
  s_mov_b32 s40, s8
  s_mov_b32 s41, s9
  s_mov_b32 s42, 0x80000
  s_mov_b32 s43, 0x20000
  s_mov_b32 s44, s14
  s_mov_b32 s45, s15
  s_mov_b32 s46, 0x80000
  s_mov_b32 s47, 0x20000
  s_mov_b32 s48, s18
  s_mov_b32 s49, s19
  s_mov_b32 s50, 0x200000
  s_mov_b32 s51, 0x20000
  s_mov_b32 s52, s20
  s_mov_b32 s53, s21
  s_mov_b32 s54, 0x100
  s_mov_b32 s55, 0x20000
  s_bfe_u32 s76, s2, 0x20001
  s_andn2_b32 s77, 1, s2
  s_lshl_b32 s77, s77, 2
  s_add_u32 s76, s76, s77
  s_bfe_u32 s77, s2, 0x20003
  s_lshr_b32 s78, s2, 5
  s_lshl_b32 s79, s58, 2
  s_add_u32 s79, s79, s60
  s_lshl_b32 s79, s79, 7
  s_add_u32 s79, s79, 12582912
  s_lshl_b32 s62, s57, 2
  s_add_u32 s62, s62, s60
  s_lshl_b32 s62, s62, 17
  s_lshl_b32 s63, s58, 1
  s_lshr_b32 s64, s56, 2
  s_add_u32 s63, s63, s64
  s_lshl_b32 s63, s63, 10
  s_add_u32 s62, s62, s63
  s_add_u32 s4, s62, 8388608
  s_lshl_b32 s62, s76, 3
  s_lshl_b32 s63, s77, 1
  s_add_u32 s62, s62, s63
  s_and_b32 s63, s56, 1
  s_add_u32 s62, s62, s63
  s_lshl_b32 s62, s62, 16
  s_lshr_b32 s63, s56, 1
  s_lshl_b32 s63, s63, 15
  s_add_u32 s62, s62, s63
  s_add_u32 s5, s62, 8388608
  s_lshl_b32 s62, s76, 8
  s_lshl_b32 s63, s77, 6
  s_add_u32 s62, s62, s63
  s_lshl_b32 s62, s62, 10
  s_lshl_b32 s63, s78, 7
  s_add_u32 s6, s62, s63
  s_lshr_b32 s7, s58, 4
  s_lshl_b32 s13, s7, 7
  s_and_b32 s62, s58, 15
  s_lshl_b32 s62, s62, 2
  s_add_u32 s13, s13, s62
  s_add_u32 s13, s13, 8
  s_mul_i32 s7, s7, 0x3f800000
  s_cmp_lg_u32 s56, 0
  s_cbranch_scc1 L_nozero
  s_lshl_b32 s62, s58, 9
  s_lshl_b32 s63, s57, 2
  s_add_u32 s62, s62, s63
  s_add_u32 s62, s62, 12582912
  v_lshlrev_b32 v2, 7, v0
  v_add_u32 v2, s62, v2
  v_mov_b32 v4, 0
  s_mov_b64 exec, 0xf
  buffer_store_dword v4, v2, s[36:39], 0 offen sc1
  s_mov_b64 exec, -1
L_nozero:
  v_and_b32 v253, 31, v0
  v_lshlrev_b32 v253, 2, v253
  s_lshl_b32 s3, s57, 10
  s_lshl_b32 s63, s60, 8
  s_add_u32 s3, s3, s63
  s_add_u32 s3, s3, 12615680
  v_mov_b32 v232, -1
  v_mov_b32 v233, -1
  v_mov_b32 v234, -1
  v_mov_b32 v235, -1
  v_mov_b32 v236, 0
  v_mov_b32 v237, 0
  v_mov_b32 v238, 0
  v_mov_b32 v239, 0
  v_mov_b32 v231, 0xdddd
  v_and_b32 v230, 0x33, v0
  v_bfe_u32 v254, v0, 2, 1
  v_lshl_or_b32 v230, v254, 3, v230
  v_bfe_u32 v254, v0, 3, 1
  v_lshl_or_b32 v230, v254, 2, v230
  v_lshlrev_b32 v230, 4, v230
  v_and_b32 v254, 1, v0
  v_lshlrev_b32 v254, 7, v254
  v_mov_b32 v255, 128
  s_lshl_b32 s70, s58, 18
  s_lshl_b32 s63, s56, 12
  s_add_u32 s70, s70, s63
  s_mul_i32 s72, s56, 4160
  s_lshl_b32 s73, s56, 13
  s_lshl_b32 s63, s78, 7
  s_add_u32 s73, s73, s63
  s_lshl_b32 s74, s56, 10
  s_andn2_b32 s63, 4, s57
  s_lshl_b32 s63, s63, 15
  s_add_u32 s12, s70, s63
  v_and_b32 v2, 1, v0
  v_lshlrev_b32 v249, 7, v2
  v_mov_b32 v252, 1
  v_lshlrev_b32 v246, 4, v0
  s_lshr_b32 s62, s56, 2
  s_mul_i32 s62, s62, 16640
  v_add_u32 v240, s62, v246
  v_lshrrev_b32 v104, 5, v0
  v_and_b32 v105, 15, v0
  v_lshlrev_b32 v105, 4, v105
  v_lshl_add_u32 v105, v104, 8, v105
  v_add_u32 v105, 1024, v105
  v_add_u32 v106, 512, v105
  v_and_b32 v104, 11, v0
  v_cmp_eq_u32 vcc, 0, v104
  v_mov_b32 v107, 2064
  v_mov_b32 v108, 2048
  v_cndmask_b32 v107, v107, v108, vcc
  v_and_b32 v104, 16, v0
  v_cmp_eq_u32 vcc, 0, v104
  s_nop 1
  v_cndmask_b32 v105, v107, v105, vcc
  v_cndmask_b32 v106, v107, v106, vcc
  v_add_u32 v241, s62, v105
  v_add_u32 v242, s62, v106
  v_add_u32 v243, 130560, v240
  v_add_u32 v244, 130560, v241
  v_add_u32 v245, 130560, v242
  v_lshrrev_b32 v104, 3, v0
  v_lshlrev_b32 v104, 10, v104
  v_and_b32 v105, 7, v0
  v_lshlrev_b32 v248, 2, v105
  v_bfe_u32 v106, v0, 4, 1
  v_lshlrev_b32 v106, 2, v106
  v_xor_b32 v105, v105, v106
  v_lshl_add_u32 v247, v105, 4, v104
  v_and_b32 v13, 31, v0
  v_lshrrev_b32 v14, 5, v0
  v_bfe_u32 v15, v0, 1, 3
  v_xor_b32 v15, v15, v14
  v_lshlrev_b32 v13, 7, v13
  s_lshl_b32 s62, s60, 13
  v_add_u32 v13, s62, v13
  v_xor_b32 v14, 0, v15
  v_lshl_add_u32 v2, v14, 4, v13
  v_add_u32 v6, 0x10000, v2
  v_xor_b32 v14, 2, v15
  v_lshl_add_u32 v3, v14, 4, v13
  v_add_u32 v7, 0x10000, v3
  v_xor_b32 v14, 4, v15
  v_lshl_add_u32 v4, v14, 4, v13
  v_add_u32 v8, 0x10000, v4
  v_xor_b32 v14, 6, v15
  v_lshl_add_u32 v5, v14, 4, v13
  v_add_u32 v9, 0x10000, v5
  v_lshrrev_b32 v13, 5, v0
  v_lshlrev_b32 v13, 3, v13
  v_bfe_u32 v14, v0, 2, 2
  v_add_u32 v13, v13, v14
  v_lshlrev_b32 v13, 6, v13
  v_and_b32 v14, 3, v0
  v_lshl_add_u32 v13, v14, 3, v13
  v_add_u32 v13, 98304, v13
  v_bfe_u32 v14, v0, 4, 1
  v_mul_u32_u24 v15, 1056, v14
  v_add_u32 v10, v13, v15
  v_mul_u32_u24 v15, 992, v14
  v_add3_u32 v11, v13, v15, 32
  v_lshl_add_u32 v13, v14, 5, v13
  v_add_u32 v12, 2048, v13
  s_lshl_b32 s68, s68, 3
  s_add_u32 s68, s68, 12615680
  v_lshrrev_b32 v13, 5, v0
  v_lshlrev_b32 v13, 2, v13
  v_mov_b32 v44, 0
  v_mov_b32 v45, 0
  s_waitcnt vmcnt(0)
  v_dot2_f32_bf16 v44, v32, v40, v44
  v_dot2_f32_bf16 v45, v36, v40, v45
  v_dot2_f32_bf16 v44, v33, v41, v44
  v_dot2_f32_bf16 v45, v37, v41, v45
  v_dot2_f32_bf16 v44, v34, v42, v44
  v_dot2_f32_bf16 v45, v38, v42, v45
  v_dot2_f32_bf16 v44, v35, v43, v44
  v_dot2_f32_bf16 v45, v39, v43, v45
  s_nop 2
  v_permlane32_swap_b32 v44, v45
  v_add_f32 v44, v44, v45
  v_mov_b32 v45, v44
  s_nop 1
  v_permlane16_swap_b32 v44, v45
  v_add_f32 v44, v44, v45
  s_nop 1
  v_add_f32_dpp v44, v44, v44 quad_perm:[1,0,3,2] row_mask:0xf bank_mask:0xf
  s_nop 1
  v_add_f32_dpp v44, v44, v44 quad_perm:[2,3,0,1] row_mask:0xf bank_mask:0xf
  s_nop 1
  v_add_f32_dpp v44, v44, v44 row_half_mirror row_mask:0xf bank_mask:0xf
  s_nop 1
  v_add_f32_dpp v44, v44, v44 row_mirror row_mask:0xf bank_mask:0xf
  v_mul_f32 v44, 0xbfb8aa3b, v44
  v_exp_f32 v44, v44
  s_nop 0
  v_add_f32 v44, 1.0, v44
  v_rcp_f32 v44, v44
  s_mov_b32 exec_lo, 1
  s_mov_b32 exec_hi, 1
  buffer_store_dword v44, v13, s[36:39], s68 offen sc1
  s_mov_b64 exec, -1
  s_barrier
  ds_read_b128 v[128:131], v2 offset:32768
  ds_read_b64_tr_b16 v[136:137], v10 offset:0
  ds_read_b64_tr_b16 v[138:139], v10 offset:256
  ds_read_b128 v[132:135], v2 offset:36864
  ds_read_b64_tr_b16 v[140:141], v11 offset:0
  ds_read_b64_tr_b16 v[142:143], v11 offset:256
  ds_read_b64_tr_b16 v[144:145], v12 offset:0
  ds_read_b64_tr_b16 v[146:147], v12 offset:256
  s_waitcnt lgkmcnt(0)
  v_mfma_f32_32x32x16_bf16 v[32:47], v[136:139], v[128:131], 0
  ds_read_b128 v[148:151], v3 offset:32768
  ds_read_b64_tr_b16 v[156:157], v10 offset:3072
  ds_read_b64_tr_b16 v[158:159], v10 offset:3328
  v_mfma_f32_32x32x16_bf16 v[48:63], v[136:139], v[132:135], 0
  ds_read_b128 v[152:155], v3 offset:36864
  ds_read_b64_tr_b16 v[160:161], v11 offset:3072
  ds_read_b64_tr_b16 v[162:163], v11 offset:3328
  v_mfma_f32_32x32x16_bf16 v[64:79], v[140:143], v[128:131], 0
  ds_read_b64_tr_b16 v[164:165], v12 offset:3072
  ds_read_b64_tr_b16 v[166:167], v12 offset:3328
  v_mfma_f32_32x32x16_bf16 v[80:95], v[140:143], v[132:135], 0
  v_mfma_f32_32x32x16_bf16 v[96:111], v[128:131], v[144:147], 0
  v_mfma_f32_32x32x16_bf16 v[112:127], v[132:135], v[144:147], 0
  s_waitcnt lgkmcnt(0)
  v_mfma_f32_32x32x16_bf16 v[32:47], v[156:159], v[148:151], v[32:47]
  ds_read_b128 v[128:131], v4 offset:32768
  ds_read_b64_tr_b16 v[136:137], v10 offset:6144
  ds_read_b64_tr_b16 v[138:139], v10 offset:6400
  v_mfma_f32_32x32x16_bf16 v[48:63], v[156:159], v[152:155], v[48:63]
  ds_read_b128 v[132:135], v4 offset:36864
  ds_read_b64_tr_b16 v[140:141], v11 offset:6144
  ds_read_b64_tr_b16 v[142:143], v11 offset:6400
  v_mfma_f32_32x32x16_bf16 v[64:79], v[160:163], v[148:151], v[64:79]
  ds_read_b64_tr_b16 v[144:145], v12 offset:6144
  ds_read_b64_tr_b16 v[146:147], v12 offset:6400
  v_mfma_f32_32x32x16_bf16 v[80:95], v[160:163], v[152:155], v[80:95]
  v_mfma_f32_32x32x16_bf16 v[96:111], v[148:151], v[164:167], v[96:111]
  v_mfma_f32_32x32x16_bf16 v[112:127], v[152:155], v[164:167], v[112:127]
  s_waitcnt lgkmcnt(0)
  v_mfma_f32_32x32x16_bf16 v[32:47], v[136:139], v[128:131], v[32:47]
  ds_read_b128 v[148:151], v5 offset:32768
  ds_read_b64_tr_b16 v[156:157], v10 offset:9216
  ds_read_b64_tr_b16 v[158:159], v10 offset:9472
  v_mfma_f32_32x32x16_bf16 v[48:63], v[136:139], v[132:135], v[48:63]
  ds_read_b128 v[152:155], v5 offset:36864
  ds_read_b64_tr_b16 v[160:161], v11 offset:9216
  ds_read_b64_tr_b16 v[162:163], v11 offset:9472
  v_mfma_f32_32x32x16_bf16 v[64:79], v[140:143], v[128:131], v[64:79]
  ds_read_b64_tr_b16 v[164:165], v12 offset:9216
  ds_read_b64_tr_b16 v[166:167], v12 offset:9472
  v_mfma_f32_32x32x16_bf16 v[80:95], v[140:143], v[132:135], v[80:95]
  v_mfma_f32_32x32x16_bf16 v[96:111], v[128:131], v[144:147], v[96:111]
  v_mfma_f32_32x32x16_bf16 v[112:127], v[132:135], v[144:147], v[112:127]
  s_waitcnt lgkmcnt(0)
  s_barrier
  v_mfma_f32_32x32x16_bf16 v[32:47], v[156:159], v[148:151], v[32:47]
  ds_read_b128 v[128:131], v2 offset:0
  ds_read_b64_tr_b16 v[136:137], v10 offset:12288
  ds_read_b64_tr_b16 v[138:139], v10 offset:12544
  v_mfma_f32_32x32x16_bf16 v[48:63], v[156:159], v[152:155], v[48:63]
  ds_read_b128 v[132:135], v2 offset:4096
  ds_read_b64_tr_b16 v[140:141], v11 offset:12288
  ds_read_b64_tr_b16 v[142:143], v11 offset:12544
  v_mfma_f32_32x32x16_bf16 v[64:79], v[160:163], v[148:151], v[64:79]
  ds_read_b64_tr_b16 v[144:145], v12 offset:12288
  ds_read_b64_tr_b16 v[146:147], v12 offset:12544
  v_mfma_f32_32x32x16_bf16 v[80:95], v[160:163], v[152:155], v[80:95]
  v_mfma_f32_32x32x16_bf16 v[96:111], v[148:151], v[164:167], v[96:111]
  v_mfma_f32_32x32x16_bf16 v[112:127], v[152:155], v[164:167], v[112:127]
  s_waitcnt lgkmcnt(0)
  v_mfma_f32_32x32x16_bf16 v[32:47], v[136:139], v[128:131], v[32:47]
  ds_read_b128 v[148:151], v3 offset:0
  ds_read_b64_tr_b16 v[156:157], v10 offset:15360
  ds_read_b64_tr_b16 v[158:159], v10 offset:15616
  v_mfma_f32_32x32x16_bf16 v[48:63], v[136:139], v[132:135], v[48:63]
  ds_read_b128 v[152:155], v3 offset:4096
  ds_read_b64_tr_b16 v[160:161], v11 offset:15360
  ds_read_b64_tr_b16 v[162:163], v11 offset:15616
  v_mfma_f32_32x32x16_bf16 v[64:79], v[140:143], v[128:131], v[64:79]
  ds_read_b64_tr_b16 v[164:165], v12 offset:15360
  ds_read_b64_tr_b16 v[166:167], v12 offset:15616
  v_mfma_f32_32x32x16_bf16 v[80:95], v[140:143], v[132:135], v[80:95]
  v_mfma_f32_32x32x16_bf16 v[96:111], v[128:131], v[144:147], v[96:111]
  v_mfma_f32_32x32x16_bf16 v[112:127], v[132:135], v[144:147], v[112:127]
  s_waitcnt lgkmcnt(0)
  v_mfma_f32_32x32x16_bf16 v[32:47], v[156:159], v[148:151], v[32:47]
  ds_read_b128 v[128:131], v4 offset:0
  ds_read_b64_tr_b16 v[136:137], v10 offset:18432
  ds_read_b64_tr_b16 v[138:139], v10 offset:18688
  v_mfma_f32_32x32x16_bf16 v[48:63], v[156:159], v[152:155], v[48:63]
  ds_read_b128 v[132:135], v4 offset:4096
  ds_read_b64_tr_b16 v[140:141], v11 offset:18432
  ds_read_b64_tr_b16 v[142:143], v11 offset:18688
  v_mfma_f32_32x32x16_bf16 v[64:79], v[160:163], v[148:151], v[64:79]
  ds_read_b64_tr_b16 v[144:145], v12 offset:18432
  ds_read_b64_tr_b16 v[146:147], v12 offset:18688
  v_mfma_f32_32x32x16_bf16 v[80:95], v[160:163], v[152:155], v[80:95]
  v_mfma_f32_32x32x16_bf16 v[96:111], v[148:151], v[164:167], v[96:111]
  v_mfma_f32_32x32x16_bf16 v[112:127], v[152:155], v[164:167], v[112:127]
  s_waitcnt lgkmcnt(0)
  v_mfma_f32_32x32x16_bf16 v[32:47], v[136:139], v[128:131], v[32:47]
  ds_read_b128 v[148:151], v5 offset:0
  ds_read_b64_tr_b16 v[156:157], v10 offset:21504
  ds_read_b64_tr_b16 v[158:159], v10 offset:21760
  v_mfma_f32_32x32x16_bf16 v[48:63], v[136:139], v[132:135], v[48:63]
  ds_read_b128 v[152:155], v5 offset:4096
  ds_read_b64_tr_b16 v[160:161], v11 offset:21504
  ds_read_b64_tr_b16 v[162:163], v11 offset:21760
  v_mfma_f32_32x32x16_bf16 v[64:79], v[140:143], v[128:131], v[64:79]
  ds_read_b64_tr_b16 v[164:165], v12 offset:21504
  ds_read_b64_tr_b16 v[166:167], v12 offset:21760
  v_mfma_f32_32x32x16_bf16 v[80:95], v[140:143], v[132:135], v[80:95]
  v_mfma_f32_32x32x16_bf16 v[96:111], v[128:131], v[144:147], v[96:111]
  v_mfma_f32_32x32x16_bf16 v[112:127], v[132:135], v[144:147], v[112:127]
  s_waitcnt lgkmcnt(0)
  s_barrier
  v_mfma_f32_32x32x16_bf16 v[32:47], v[156:159], v[148:151], v[32:47]
  ds_read_b128 v[128:131], v6 offset:0
  ds_read_b64_tr_b16 v[136:137], v10 offset:24576
  ds_read_b64_tr_b16 v[138:139], v10 offset:24832
  v_mfma_f32_32x32x16_bf16 v[48:63], v[156:159], v[152:155], v[48:63]
  ds_read_b128 v[132:135], v6 offset:4096
  ds_read_b64_tr_b16 v[140:141], v11 offset:24576
  ds_read_b64_tr_b16 v[142:143], v11 offset:24832
  v_mfma_f32_32x32x16_bf16 v[64:79], v[160:163], v[148:151], v[64:79]
  ds_read_b64_tr_b16 v[144:145], v12 offset:24576
  ds_read_b64_tr_b16 v[146:147], v12 offset:24832
  v_mfma_f32_32x32x16_bf16 v[80:95], v[160:163], v[152:155], v[80:95]
  v_mfma_f32_32x32x16_bf16 v[96:111], v[148:151], v[164:167], v[96:111]
  v_mfma_f32_32x32x16_bf16 v[112:127], v[152:155], v[164:167], v[112:127]
  s_waitcnt lgkmcnt(0)
  v_mfma_f32_32x32x16_bf16 v[32:47], v[136:139], v[128:131], v[32:47]
  ds_read_b128 v[148:151], v7 offset:0
  ds_read_b64_tr_b16 v[156:157], v10 offset:27648
  ds_read_b64_tr_b16 v[158:159], v10 offset:27904
  v_mfma_f32_32x32x16_bf16 v[48:63], v[136:139], v[132:135], v[48:63]
  ds_read_b128 v[152:155], v7 offset:4096
  ds_read_b64_tr_b16 v[160:161], v11 offset:27648
  ds_read_b64_tr_b16 v[162:163], v11 offset:27904
  v_mfma_f32_32x32x16_bf16 v[64:79], v[140:143], v[128:131], v[64:79]
  ds_read_b64_tr_b16 v[164:165], v12 offset:27648
  ds_read_b64_tr_b16 v[166:167], v12 offset:27904
  v_mfma_f32_32x32x16_bf16 v[80:95], v[140:143], v[132:135], v[80:95]
  s_cmp_lg_u32 s56, 0
  s_cbranch_scc1 L_noz0
  s_mov_b64 exec, 1
  buffer_atomic_add v252, off, s[52:55], s13
  s_mov_b64 exec, -1
L_noz0:
  v_mfma_f32_32x32x16_bf16 v[96:111], v[128:131], v[144:147], v[96:111]
  v_mfma_f32_32x32x16_bf16 v[112:127], v[132:135], v[144:147], v[112:127]
  s_waitcnt lgkmcnt(0)
  v_mfma_f32_32x32x16_bf16 v[32:47], v[156:159], v[148:151], v[32:47]
  ds_read_b128 v[128:131], v8 offset:0
  ds_read_b64_tr_b16 v[136:137], v10 offset:30720
  ds_read_b64_tr_b16 v[138:139], v10 offset:30976
  v_mfma_f32_32x32x16_bf16 v[48:63], v[156:159], v[152:155], v[48:63]
  ds_read_b128 v[132:135], v8 offset:4096
  ds_read_b64_tr_b16 v[140:141], v11 offset:30720
  ds_read_b64_tr_b16 v[142:143], v11 offset:30976
  v_mfma_f32_32x32x16_bf16 v[64:79], v[160:163], v[148:151], v[64:79]
  ds_read_b64_tr_b16 v[144:145], v12 offset:30720
  ds_read_b64_tr_b16 v[146:147], v12 offset:30976
  v_mfma_f32_32x32x16_bf16 v[80:95], v[160:163], v[152:155], v[80:95]
  v_mfma_f32_32x32x16_bf16 v[96:111], v[148:151], v[164:167], v[96:111]
  v_mfma_f32_32x32x16_bf16 v[112:127], v[152:155], v[164:167], v[112:127]
  s_waitcnt lgkmcnt(0)
  v_mfma_f32_32x32x16_bf16 v[32:47], v[136:139], v[128:131], v[32:47]
  ds_read_b128 v[148:151], v9 offset:0
  ds_read_b64_tr_b16 v[156:157], v10 offset:33792
  ds_read_b64_tr_b16 v[158:159], v10 offset:34048
  v_mfma_f32_32x32x16_bf16 v[48:63], v[136:139], v[132:135], v[48:63]
  ds_read_b128 v[152:155], v9 offset:4096
  ds_read_b64_tr_b16 v[160:161], v11 offset:33792
  ds_read_b64_tr_b16 v[162:163], v11 offset:34048
  v_mfma_f32_32x32x16_bf16 v[64:79], v[140:143], v[128:131], v[64:79]
  ds_read_b64_tr_b16 v[164:165], v12 offset:33792
  ds_read_b64_tr_b16 v[166:167], v12 offset:34048
  v_mfma_f32_32x32x16_bf16 v[80:95], v[140:143], v[132:135], v[80:95]
  v_mfma_f32_32x32x16_bf16 v[96:111], v[128:131], v[144:147], v[96:111]
  v_mfma_f32_32x32x16_bf16 v[112:127], v[132:135], v[144:147], v[112:127]
  s_waitcnt lgkmcnt(0)
  s_barrier
  v_mfma_f32_32x32x16_bf16 v[32:47], v[156:159], v[148:151], v[32:47]
  ds_read_b128 v[128:131], v2 offset:32768
  ds_read_b64_tr_b16 v[136:137], v10 offset:0
  ds_read_b64_tr_b16 v[138:139], v10 offset:256
  v_mfma_f32_32x32x16_bf16 v[48:63], v[156:159], v[152:155], v[48:63]
  ds_read_b128 v[132:135], v2 offset:36864
  ds_read_b64_tr_b16 v[140:141], v11 offset:0
  ds_read_b64_tr_b16 v[142:143], v11 offset:256
  v_mfma_f32_32x32x16_bf16 v[64:79], v[160:163], v[148:151], v[64:79]
  ds_read_b64_tr_b16 v[144:145], v12 offset:0
  ds_read_b64_tr_b16 v[146:147], v12 offset:256
  v_mfma_f32_32x32x16_bf16 v[80:95], v[160:163], v[152:155], v[80:95]
  v_mfma_f32_32x32x16_bf16 v[96:111], v[148:151], v[164:167], v[96:111]
  v_mfma_f32_32x32x16_bf16 v[112:127], v[152:155], v[164:167], v[112:127]
  s_waitcnt lgkmcnt(0)
  v_mfma_f32_32x32x16_bf16 v[32:47], v[136:139], v[128:131], v[32:47]
  ds_read_b128 v[148:151], v3 offset:32768
  ds_read_b64_tr_b16 v[156:157], v10 offset:3072
  ds_read_b64_tr_b16 v[158:159], v10 offset:3328
  v_mfma_f32_32x32x16_bf16 v[48:63], v[136:139], v[132:135], v[48:63]
  ds_read_b128 v[152:155], v3 offset:36864
  ds_read_b64_tr_b16 v[160:161], v11 offset:3072
  ds_read_b64_tr_b16 v[162:163], v11 offset:3328
  v_mfma_f32_32x32x16_bf16 v[64:79], v[140:143], v[128:131], v[64:79]
  ds_read_b64_tr_b16 v[164:165], v12 offset:3072
  ds_read_b64_tr_b16 v[166:167], v12 offset:3328
  v_mfma_f32_32x32x16_bf16 v[80:95], v[140:143], v[132:135], v[80:95]
  v_mfma_f32_32x32x16_bf16 v[96:111], v[128:131], v[144:147], v[96:111]
  v_mfma_f32_32x32x16_bf16 v[112:127], v[132:135], v[144:147], v[112:127]
  s_waitcnt lgkmcnt(0)
  v_mfma_f32_32x32x16_bf16 v[32:47], v[156:159], v[148:151], v[32:47]
  ds_read_b128 v[128:131], v4 offset:32768
  ds_read_b64_tr_b16 v[136:137], v10 offset:6144
  ds_read_b64_tr_b16 v[138:139], v10 offset:6400
  v_mfma_f32_32x32x16_bf16 v[48:63], v[156:159], v[152:155], v[48:63]
  ds_read_b128 v[132:135], v4 offset:36864
  ds_read_b64_tr_b16 v[140:141], v11 offset:6144
  ds_read_b64_tr_b16 v[142:143], v11 offset:6400
  v_mfma_f32_32x32x16_bf16 v[64:79], v[160:163], v[148:151], v[64:79]
  ds_read_b64_tr_b16 v[144:145], v12 offset:6144
  ds_read_b64_tr_b16 v[146:147], v12 offset:6400
  v_mfma_f32_32x32x16_bf16 v[80:95], v[160:163], v[152:155], v[80:95]
  v_mfma_f32_32x32x16_bf16 v[96:111], v[148:151], v[164:167], v[96:111]
  v_mfma_f32_32x32x16_bf16 v[112:127], v[152:155], v[164:167], v[112:127]
  s_waitcnt lgkmcnt(0)
  v_mfma_f32_32x32x16_bf16 v[32:47], v[136:139], v[128:131], v[32:47]
  ds_read_b128 v[148:151], v5 offset:32768
  ds_read_b64_tr_b16 v[156:157], v10 offset:9216
  ds_read_b64_tr_b16 v[158:159], v10 offset:9472
  v_mfma_f32_32x32x16_bf16 v[48:63], v[136:139], v[132:135], v[48:63]
  ds_read_b128 v[152:155], v5 offset:36864
  ds_read_b64_tr_b16 v[160:161], v11 offset:9216
  ds_read_b64_tr_b16 v[162:163], v11 offset:9472
  v_mfma_f32_32x32x16_bf16 v[64:79], v[140:143], v[128:131], v[64:79]
  ds_read_b64_tr_b16 v[164:165], v12 offset:9216
  ds_read_b64_tr_b16 v[166:167], v12 offset:9472
  v_mfma_f32_32x32x16_bf16 v[80:95], v[140:143], v[132:135], v[80:95]
  v_mfma_f32_32x32x16_bf16 v[96:111], v[128:131], v[144:147], v[96:111]
  v_mfma_f32_32x32x16_bf16 v[112:127], v[132:135], v[144:147], v[112:127]
  s_waitcnt lgkmcnt(0)
  s_barrier
  v_mfma_f32_32x32x16_bf16 v[32:47], v[156:159], v[148:151], v[32:47]
  ds_read_b128 v[128:131], v2 offset:0
  ds_read_b64_tr_b16 v[136:137], v10 offset:12288
  ds_read_b64_tr_b16 v[138:139], v10 offset:12544
  v_mfma_f32_32x32x16_bf16 v[48:63], v[156:159], v[152:155], v[48:63]
  ds_read_b128 v[132:135], v2 offset:4096
  ds_read_b64_tr_b16 v[140:141], v11 offset:12288
  ds_read_b64_tr_b16 v[142:143], v11 offset:12544
  v_mfma_f32_32x32x16_bf16 v[64:79], v[160:163], v[148:151], v[64:79]
  ds_read_b64_tr_b16 v[144:145], v12 offset:12288
  ds_read_b64_tr_b16 v[146:147], v12 offset:12544
  v_mfma_f32_32x32x16_bf16 v[80:95], v[160:163], v[152:155], v[80:95]
  v_mfma_f32_32x32x16_bf16 v[96:111], v[148:151], v[164:167], v[96:111]
  v_mfma_f32_32x32x16_bf16 v[112:127], v[152:155], v[164:167], v[112:127]
  s_waitcnt lgkmcnt(0)
  v_mfma_f32_32x32x16_bf16 v[32:47], v[136:139], v[128:131], v[32:47]
  ds_read_b128 v[148:151], v3 offset:0
  ds_read_b64_tr_b16 v[156:157], v10 offset:15360
  ds_read_b64_tr_b16 v[158:159], v10 offset:15616
  v_mfma_f32_32x32x16_bf16 v[48:63], v[136:139], v[132:135], v[48:63]
  ds_read_b128 v[152:155], v3 offset:4096
  ds_read_b64_tr_b16 v[160:161], v11 offset:15360
  ds_read_b64_tr_b16 v[162:163], v11 offset:15616
  v_mfma_f32_32x32x16_bf16 v[64:79], v[140:143], v[128:131], v[64:79]
  ds_read_b64_tr_b16 v[164:165], v12 offset:15360
  ds_read_b64_tr_b16 v[166:167], v12 offset:15616
  v_mfma_f32_32x32x16_bf16 v[80:95], v[140:143], v[132:135], v[80:95]
  v_mfma_f32_32x32x16_bf16 v[96:111], v[128:131], v[144:147], v[96:111]
  v_mfma_f32_32x32x16_bf16 v[112:127], v[132:135], v[144:147], v[112:127]
  s_waitcnt lgkmcnt(0)
  v_mfma_f32_32x32x16_bf16 v[32:47], v[156:159], v[148:151], v[32:47]
  ds_read_b128 v[128:131], v4 offset:0
  ds_read_b64_tr_b16 v[136:137], v10 offset:18432
  ds_read_b64_tr_b16 v[138:139], v10 offset:18688
  v_mfma_f32_32x32x16_bf16 v[48:63], v[156:159], v[152:155], v[48:63]
  ds_read_b128 v[132:135], v4 offset:4096
  ds_read_b64_tr_b16 v[140:141], v11 offset:18432
  ds_read_b64_tr_b16 v[142:143], v11 offset:18688
  v_mfma_f32_32x32x16_bf16 v[64:79], v[160:163], v[148:151], v[64:79]
  ds_read_b64_tr_b16 v[144:145], v12 offset:18432
  ds_read_b64_tr_b16 v[146:147], v12 offset:18688
  v_mfma_f32_32x32x16_bf16 v[80:95], v[160:163], v[152:155], v[80:95]
  v_mfma_f32_32x32x16_bf16 v[96:111], v[148:151], v[164:167], v[96:111]
  v_mfma_f32_32x32x16_bf16 v[112:127], v[152:155], v[164:167], v[112:127]
  s_waitcnt lgkmcnt(0)
  v_mfma_f32_32x32x16_bf16 v[32:47], v[136:139], v[128:131], v[32:47]
  ds_read_b128 v[148:151], v5 offset:0
  ds_read_b64_tr_b16 v[156:157], v10 offset:21504
  ds_read_b64_tr_b16 v[158:159], v10 offset:21760
  v_mfma_f32_32x32x16_bf16 v[48:63], v[136:139], v[132:135], v[48:63]
  ds_read_b128 v[152:155], v5 offset:4096
  ds_read_b64_tr_b16 v[160:161], v11 offset:21504
  ds_read_b64_tr_b16 v[162:163], v11 offset:21760
  v_mfma_f32_32x32x16_bf16 v[64:79], v[140:143], v[128:131], v[64:79]
  ds_read_b64_tr_b16 v[164:165], v12 offset:21504
  ds_read_b64_tr_b16 v[166:167], v12 offset:21760
  v_mfma_f32_32x32x16_bf16 v[80:95], v[140:143], v[132:135], v[80:95]
  v_mfma_f32_32x32x16_bf16 v[96:111], v[128:131], v[144:147], v[96:111]
  v_mfma_f32_32x32x16_bf16 v[112:127], v[132:135], v[144:147], v[112:127]
  s_waitcnt lgkmcnt(0)
  s_barrier
  v_mfma_f32_32x32x16_bf16 v[32:47], v[156:159], v[148:151], v[32:47]
  ds_read_b128 v[128:131], v6 offset:0
  ds_read_b64_tr_b16 v[136:137], v10 offset:24576
  ds_read_b64_tr_b16 v[138:139], v10 offset:24832
  v_mfma_f32_32x32x16_bf16 v[48:63], v[156:159], v[152:155], v[48:63]
  ds_read_b128 v[132:135], v6 offset:4096
  ds_read_b64_tr_b16 v[140:141], v11 offset:24576
  ds_read_b64_tr_b16 v[142:143], v11 offset:24832
  v_mfma_f32_32x32x16_bf16 v[64:79], v[160:163], v[148:151], v[64:79]
  ds_read_b64_tr_b16 v[144:145], v12 offset:24576
  ds_read_b64_tr_b16 v[146:147], v12 offset:24832
  v_mfma_f32_32x32x16_bf16 v[80:95], v[160:163], v[152:155], v[80:95]
  v_mfma_f32_32x32x16_bf16 v[96:111], v[148:151], v[164:167], v[96:111]
  v_mfma_f32_32x32x16_bf16 v[112:127], v[152:155], v[164:167], v[112:127]
  s_waitcnt lgkmcnt(0)
  v_mfma_f32_32x32x16_bf16 v[32:47], v[136:139], v[128:131], v[32:47]
  ds_read_b128 v[148:151], v7 offset:0
  ds_read_b64_tr_b16 v[156:157], v10 offset:27648
  ds_read_b64_tr_b16 v[158:159], v10 offset:27904
  v_mfma_f32_32x32x16_bf16 v[48:63], v[136:139], v[132:135], v[48:63]
  ds_read_b128 v[152:155], v7 offset:4096
  ds_read_b64_tr_b16 v[160:161], v11 offset:27648
  ds_read_b64_tr_b16 v[162:163], v11 offset:27904
  v_mfma_f32_32x32x16_bf16 v[64:79], v[140:143], v[128:131], v[64:79]
  ds_read_b64_tr_b16 v[164:165], v12 offset:27648
  ds_read_b64_tr_b16 v[166:167], v12 offset:27904
  v_mfma_f32_32x32x16_bf16 v[80:95], v[140:143], v[132:135], v[80:95]
  v_mfma_f32_32x32x16_bf16 v[96:111], v[128:131], v[144:147], v[96:111]
  v_mfma_f32_32x32x16_bf16 v[112:127], v[132:135], v[144:147], v[112:127]
  s_waitcnt lgkmcnt(0)
  v_mfma_f32_32x32x16_bf16 v[32:47], v[156:159], v[148:151], v[32:47]
  ds_read_b128 v[128:131], v8 offset:0
  ds_read_b64_tr_b16 v[136:137], v10 offset:30720
  ds_read_b64_tr_b16 v[138:139], v10 offset:30976
  v_mfma_f32_32x32x16_bf16 v[48:63], v[156:159], v[152:155], v[48:63]
  ds_read_b128 v[132:135], v8 offset:4096
  ds_read_b64_tr_b16 v[140:141], v11 offset:30720
  ds_read_b64_tr_b16 v[142:143], v11 offset:30976
  v_mfma_f32_32x32x16_bf16 v[64:79], v[160:163], v[148:151], v[64:79]
  ds_read_b64_tr_b16 v[144:145], v12 offset:30720
  ds_read_b64_tr_b16 v[146:147], v12 offset:30976
  v_mfma_f32_32x32x16_bf16 v[80:95], v[160:163], v[152:155], v[80:95]
  v_mfma_f32_32x32x16_bf16 v[96:111], v[148:151], v[164:167], v[96:111]
  v_mfma_f32_32x32x16_bf16 v[112:127], v[152:155], v[164:167], v[112:127]
  s_waitcnt lgkmcnt(0)
  v_mfma_f32_32x32x16_bf16 v[32:47], v[136:139], v[128:131], v[32:47]
  ds_read_b128 v[148:151], v9 offset:0
  ds_read_b64_tr_b16 v[156:157], v10 offset:33792
  ds_read_b64_tr_b16 v[158:159], v10 offset:34048
  v_mfma_f32_32x32x16_bf16 v[48:63], v[136:139], v[132:135], v[48:63]
  ds_read_b128 v[152:155], v9 offset:4096
  ds_read_b64_tr_b16 v[160:161], v11 offset:33792
  ds_read_b64_tr_b16 v[162:163], v11 offset:34048
  v_mfma_f32_32x32x16_bf16 v[64:79], v[140:143], v[128:131], v[64:79]
  ds_read_b64_tr_b16 v[164:165], v12 offset:33792
  ds_read_b64_tr_b16 v[166:167], v12 offset:34048
  v_mfma_f32_32x32x16_bf16 v[80:95], v[140:143], v[132:135], v[80:95]
  v_mfma_f32_32x32x16_bf16 v[96:111], v[128:131], v[144:147], v[96:111]
  v_mfma_f32_32x32x16_bf16 v[112:127], v[132:135], v[144:147], v[112:127]
  s_waitcnt lgkmcnt(0)
  s_barrier
  v_mfma_f32_32x32x16_bf16 v[32:47], v[156:159], v[148:151], v[32:47]
  ds_read_b128 v[128:131], v2 offset:32768
  ds_read_b64_tr_b16 v[136:137], v10 offset:0
  ds_read_b64_tr_b16 v[138:139], v10 offset:256
  v_mfma_f32_32x32x16_bf16 v[48:63], v[156:159], v[152:155], v[48:63]
  ds_read_b128 v[132:135], v2 offset:36864
  ds_read_b64_tr_b16 v[140:141], v11 offset:0
  ds_read_b64_tr_b16 v[142:143], v11 offset:256
  v_mfma_f32_32x32x16_bf16 v[64:79], v[160:163], v[148:151], v[64:79]
  ds_read_b64_tr_b16 v[144:145], v12 offset:0
  ds_read_b64_tr_b16 v[146:147], v12 offset:256
  v_mfma_f32_32x32x16_bf16 v[80:95], v[160:163], v[152:155], v[80:95]
  v_mfma_f32_32x32x16_bf16 v[96:111], v[148:151], v[164:167], v[96:111]
  v_mfma_f32_32x32x16_bf16 v[112:127], v[152:155], v[164:167], v[112:127]
  s_waitcnt lgkmcnt(0)
  v_mfma_f32_32x32x16_bf16 v[32:47], v[136:139], v[128:131], v[32:47]
  ds_read_b128 v[148:151], v3 offset:32768
  ds_read_b64_tr_b16 v[156:157], v10 offset:3072
  ds_read_b64_tr_b16 v[158:159], v10 offset:3328
  v_mfma_f32_32x32x16_bf16 v[48:63], v[136:139], v[132:135], v[48:63]
  ds_read_b128 v[152:155], v3 offset:36864
  ds_read_b64_tr_b16 v[160:161], v11 offset:3072
  ds_read_b64_tr_b16 v[162:163], v11 offset:3328
  v_mfma_f32_32x32x16_bf16 v[64:79], v[140:143], v[128:131], v[64:79]
  ds_read_b64_tr_b16 v[164:165], v12 offset:3072
  ds_read_b64_tr_b16 v[166:167], v12 offset:3328
  v_mfma_f32_32x32x16_bf16 v[80:95], v[140:143], v[132:135], v[80:95]
  v_mfma_f32_32x32x16_bf16 v[96:111], v[128:131], v[144:147], v[96:111]
  v_mfma_f32_32x32x16_bf16 v[112:127], v[132:135], v[144:147], v[112:127]
  s_waitcnt lgkmcnt(0)
  v_mfma_f32_32x32x16_bf16 v[32:47], v[156:159], v[148:151], v[32:47]
  ds_read_b128 v[128:131], v4 offset:32768
  ds_read_b64_tr_b16 v[136:137], v10 offset:6144
  ds_read_b64_tr_b16 v[138:139], v10 offset:6400
  v_mfma_f32_32x32x16_bf16 v[48:63], v[156:159], v[152:155], v[48:63]
  ds_read_b128 v[132:135], v4 offset:36864
  ds_read_b64_tr_b16 v[140:141], v11 offset:6144
  ds_read_b64_tr_b16 v[142:143], v11 offset:6400
  v_mfma_f32_32x32x16_bf16 v[64:79], v[160:163], v[148:151], v[64:79]
  ds_read_b64_tr_b16 v[144:145], v12 offset:6144
  ds_read_b64_tr_b16 v[146:147], v12 offset:6400
  v_mfma_f32_32x32x16_bf16 v[80:95], v[160:163], v[152:155], v[80:95]
  v_mfma_f32_32x32x16_bf16 v[96:111], v[148:151], v[164:167], v[96:111]
  v_mfma_f32_32x32x16_bf16 v[112:127], v[152:155], v[164:167], v[112:127]
  s_waitcnt lgkmcnt(0)
  v_mfma_f32_32x32x16_bf16 v[32:47], v[136:139], v[128:131], v[32:47]
  ds_read_b128 v[148:151], v5 offset:32768
  ds_read_b64_tr_b16 v[156:157], v10 offset:9216
  ds_read_b64_tr_b16 v[158:159], v10 offset:9472
  v_mfma_f32_32x32x16_bf16 v[48:63], v[136:139], v[132:135], v[48:63]
  ds_read_b128 v[152:155], v5 offset:36864
  ds_read_b64_tr_b16 v[160:161], v11 offset:9216
  ds_read_b64_tr_b16 v[162:163], v11 offset:9472
  v_mfma_f32_32x32x16_bf16 v[64:79], v[140:143], v[128:131], v[64:79]
  ds_read_b64_tr_b16 v[164:165], v12 offset:9216
  ds_read_b64_tr_b16 v[166:167], v12 offset:9472
  v_mfma_f32_32x32x16_bf16 v[80:95], v[140:143], v[132:135], v[80:95]
  v_mfma_f32_32x32x16_bf16 v[96:111], v[128:131], v[144:147], v[96:111]
  v_mfma_f32_32x32x16_bf16 v[112:127], v[132:135], v[144:147], v[112:127]
  s_waitcnt lgkmcnt(0)
  s_barrier
  v_mfma_f32_32x32x16_bf16 v[32:47], v[156:159], v[148:151], v[32:47]
  ds_read_b128 v[128:131], v2 offset:0
  ds_read_b64_tr_b16 v[136:137], v10 offset:12288
  ds_read_b64_tr_b16 v[138:139], v10 offset:12544
  v_mfma_f32_32x32x16_bf16 v[48:63], v[156:159], v[152:155], v[48:63]
  ds_read_b128 v[132:135], v2 offset:4096
  ds_read_b64_tr_b16 v[140:141], v11 offset:12288
  ds_read_b64_tr_b16 v[142:143], v11 offset:12544
  v_mfma_f32_32x32x16_bf16 v[64:79], v[160:163], v[148:151], v[64:79]
  ds_read_b64_tr_b16 v[144:145], v12 offset:12288
  ds_read_b64_tr_b16 v[146:147], v12 offset:12544
  v_mfma_f32_32x32x16_bf16 v[80:95], v[160:163], v[152:155], v[80:95]
  v_mfma_f32_32x32x16_bf16 v[96:111], v[148:151], v[164:167], v[96:111]
  v_mfma_f32_32x32x16_bf16 v[112:127], v[152:155], v[164:167], v[112:127]
  s_waitcnt lgkmcnt(0)
  v_mfma_f32_32x32x16_bf16 v[32:47], v[136:139], v[128:131], v[32:47]
  ds_read_b128 v[148:151], v3 offset:0
  ds_read_b64_tr_b16 v[156:157], v10 offset:15360
  ds_read_b64_tr_b16 v[158:159], v10 offset:15616
  v_mfma_f32_32x32x16_bf16 v[48:63], v[136:139], v[132:135], v[48:63]
  ds_read_b128 v[152:155], v3 offset:4096
  ds_read_b64_tr_b16 v[160:161], v11 offset:15360
  ds_read_b64_tr_b16 v[162:163], v11 offset:15616
  v_mfma_f32_32x32x16_bf16 v[64:79], v[140:143], v[128:131], v[64:79]
  ds_read_b64_tr_b16 v[164:165], v12 offset:15360
  ds_read_b64_tr_b16 v[166:167], v12 offset:15616
  v_mfma_f32_32x32x16_bf16 v[80:95], v[140:143], v[132:135], v[80:95]
  v_mfma_f32_32x32x16_bf16 v[96:111], v[128:131], v[144:147], v[96:111]
  v_mfma_f32_32x32x16_bf16 v[112:127], v[132:135], v[144:147], v[112:127]
  s_waitcnt lgkmcnt(0)
  v_mfma_f32_32x32x16_bf16 v[32:47], v[156:159], v[148:151], v[32:47]
  ds_read_b128 v[128:131], v4 offset:0
  ds_read_b64_tr_b16 v[136:137], v10 offset:18432
  ds_read_b64_tr_b16 v[138:139], v10 offset:18688
  v_mfma_f32_32x32x16_bf16 v[48:63], v[156:159], v[152:155], v[48:63]
  ds_read_b128 v[132:135], v4 offset:4096
  ds_read_b64_tr_b16 v[140:141], v11 offset:18432
  ds_read_b64_tr_b16 v[142:143], v11 offset:18688
  v_mfma_f32_32x32x16_bf16 v[64:79], v[160:163], v[148:151], v[64:79]
  ds_read_b64_tr_b16 v[144:145], v12 offset:18432
  ds_read_b64_tr_b16 v[146:147], v12 offset:18688
  v_mfma_f32_32x32x16_bf16 v[80:95], v[160:163], v[152:155], v[80:95]
  v_mfma_f32_32x32x16_bf16 v[96:111], v[148:151], v[164:167], v[96:111]
  v_mfma_f32_32x32x16_bf16 v[112:127], v[152:155], v[164:167], v[112:127]
  s_waitcnt lgkmcnt(0)
  v_mfma_f32_32x32x16_bf16 v[32:47], v[136:139], v[128:131], v[32:47]
  ds_read_b128 v[148:151], v5 offset:0
  ds_read_b64_tr_b16 v[156:157], v10 offset:21504
  ds_read_b64_tr_b16 v[158:159], v10 offset:21760
  v_mfma_f32_32x32x16_bf16 v[48:63], v[136:139], v[132:135], v[48:63]
  ds_read_b128 v[152:155], v5 offset:4096
  ds_read_b64_tr_b16 v[160:161], v11 offset:21504
  ds_read_b64_tr_b16 v[162:163], v11 offset:21760
  v_mfma_f32_32x32x16_bf16 v[64:79], v[140:143], v[128:131], v[64:79]
  ds_read_b64_tr_b16 v[164:165], v12 offset:21504
  ds_read_b64_tr_b16 v[166:167], v12 offset:21760
  v_mfma_f32_32x32x16_bf16 v[80:95], v[140:143], v[132:135], v[80:95]
  v_mfma_f32_32x32x16_bf16 v[96:111], v[128:131], v[144:147], v[96:111]
  v_mfma_f32_32x32x16_bf16 v[112:127], v[132:135], v[144:147], v[112:127]
  s_waitcnt lgkmcnt(0)
  v_mfma_f32_32x32x16_bf16 v[32:47], v[156:159], v[148:151], v[32:47]
  v_mfma_f32_32x32x16_bf16 v[48:63], v[156:159], v[152:155], v[48:63]
  v_mfma_f32_32x32x16_bf16 v[64:79], v[160:163], v[148:151], v[64:79]
  v_mfma_f32_32x32x16_bf16 v[80:95], v[160:163], v[152:155], v[80:95]
  v_mfma_f32_32x32x16_bf16 v[96:111], v[148:151], v[164:167], v[96:111]
  v_mfma_f32_32x32x16_bf16 v[112:127], v[152:155], v[164:167], v[112:127]
  s_lshl_b32 s62, s58, 3
  s_add_u32 s62, s62, s57
  s_lshl_b32 s62, s62, 15
  s_lshl_b32 s63, s60, 12
  s_add_u32 s62, s62, s63
  s_add_u32 s63, s62, 16384
  v_bfe_u32 v13, v0, 4, 1
  v_lshrrev_b32 v14, 5, v0
  v_and_b32 v15, 15, v0
  v_lshlrev_b32 v15, 4, v15
  v_lshl_add_u32 v15, v14, 8, v15
  v_add_u32 v15, 1024, v15
  v_lshl_add_u32 v3, v13, 14, v15
  s_mul_i32 s64, s60, 4160
  s_add_u32 s64, s64, 33280
  v_add_u32 v4, s64, v230
  v_mul_u32_u24 v13, 16640, v13
  v_add3_u32 v5, v13, v15, s64
  s_mov_b32 s66, 0x3eb8aa3b
  s_mov_b32 s67, 0x3eb8aa3b
  s_lshl_b32 s68, s60, 11
  s_add_u32 s68, s68, 69632
  v_add_u32 v6, s68, v246
  v_cvt_pk_bf16_f32 v128, v40, v41
  v_cvt_pk_bf16_f32 v129, v42, v43
  v_cvt_pk_bf16_f32 v130, v44, v45
  v_cvt_pk_bf16_f32 v131, v46, v47
  buffer_store_dwordx4 v[128:131], v230, s[36:39], s62 offen offset:0 sc1
  ds_write_b128 v4, v[128:131] offset:0
  v_pk_mul_f32 v[64:65], v[64:65], s[66:67]
  v_pk_mul_f32 v[66:67], v[66:67], s[66:67]
  v_pk_mul_f32 v[68:69], v[68:69], s[66:67]
  v_pk_mul_f32 v[70:71], v[70:71], s[66:67]
  v_cvt_pk_bf16_f32 v132, v56, v57
  v_cvt_pk_bf16_f32 v133, v58, v59
  v_cvt_pk_bf16_f32 v134, v60, v61
  v_cvt_pk_bf16_f32 v135, v62, v63
  buffer_store_dwordx4 v[132:135], v230, s[36:39], s62 offen offset:2048 sc1
  ds_write_b128 v4, v[132:135] offset:2080
  v_cvt_pk_bf16_f32 v16, v64, v65
  v_cvt_pk_bf16_f32 v17, v66, v67
  v_cvt_pk_bf16_f32 v18, v68, v69
  v_cvt_pk_bf16_f32 v19, v70, v71
  ds_write_b128 v6, v[16:19] offset:0
  v_cvt_pk_bf16_f32 v136, v72, v73
  v_cvt_pk_bf16_f32 v137, v74, v75
  v_cvt_pk_bf16_f32 v138, v76, v77
  v_cvt_pk_bf16_f32 v139, v78, v79
  buffer_store_dwordx4 v[136:139], v230, s[36:39], s63 offen offset:0 sc1
  ds_write_b128 v4, v[136:139] offset:16640
  v_pk_mul_f32 v[80:81], v[80:81], s[66:67]
  v_pk_mul_f32 v[82:83], v[82:83], s[66:67]
  v_pk_mul_f32 v[84:85], v[84:85], s[66:67]
  v_pk_mul_f32 v[86:87], v[86:87], s[66:67]
  v_cvt_pk_bf16_f32 v140, v88, v89
  v_cvt_pk_bf16_f32 v141, v90, v91
  v_cvt_pk_bf16_f32 v142, v92, v93
  v_cvt_pk_bf16_f32 v143, v94, v95
  buffer_store_dwordx4 v[140:143], v230, s[36:39], s63 offen offset:2048 sc1
  ds_write_b128 v4, v[140:143] offset:18720
  v_cvt_pk_bf16_f32 v20, v80, v81
  v_cvt_pk_bf16_f32 v21, v82, v83
  v_cvt_pk_bf16_f32 v22, v84, v85
  v_cvt_pk_bf16_f32 v23, v86, v87
  ds_write_b128 v6, v[20:23] offset:1024
  v_cvt_pk_bf16_f32 v144, v96, v97
  v_cvt_pk_bf16_f32 v145, v98, v99
  v_cvt_pk_bf16_f32 v146, v100, v101
  v_cvt_pk_bf16_f32 v147, v102, v103
  buffer_store_dwordx4 v[144:147], v3, s[36:39], s62 offen offset:0 sc1
  ds_write_b128 v5, v[144:147] offset:0
  v_pk_mul_f32 v[32:33], v[32:33], s[66:67]
  v_pk_mul_f32 v[34:35], v[34:35], s[66:67]
  v_pk_mul_f32 v[36:37], v[36:37], s[66:67]
  v_pk_mul_f32 v[38:39], v[38:39], s[66:67]
  v_cvt_pk_bf16_f32 v148, v104, v105
  v_cvt_pk_bf16_f32 v149, v106, v107
  v_cvt_pk_bf16_f32 v150, v108, v109
  v_cvt_pk_bf16_f32 v151, v110, v111
  buffer_store_dwordx4 v[148:151], v3, s[36:39], s62 offen offset:512 sc1
  ds_write_b128 v5, v[148:151] offset:512
  v_cvt_pk_bf16_f32 v8, v32, v33
  v_cvt_pk_bf16_f32 v9, v34, v35
  v_cvt_pk_bf16_f32 v10, v36, v37
  v_cvt_pk_bf16_f32 v11, v38, v39
  v_cvt_pk_bf16_f32 v152, v112, v113
  v_cvt_pk_bf16_f32 v153, v114, v115
  v_cvt_pk_bf16_f32 v154, v116, v117
  v_cvt_pk_bf16_f32 v155, v118, v119
  buffer_store_dwordx4 v[152:155], v3, s[36:39], s62 offen offset:2048 sc1
  ds_write_b128 v5, v[152:155] offset:2080
  v_pk_mul_f32 v[48:49], v[48:49], s[66:67]
  v_pk_mul_f32 v[50:51], v[50:51], s[66:67]
  v_pk_mul_f32 v[52:53], v[52:53], s[66:67]
  v_pk_mul_f32 v[54:55], v[54:55], s[66:67]
  v_cvt_pk_bf16_f32 v156, v120, v121
  v_cvt_pk_bf16_f32 v157, v122, v123
  v_cvt_pk_bf16_f32 v158, v124, v125
  v_cvt_pk_bf16_f32 v159, v126, v127
  buffer_store_dwordx4 v[156:159], v3, s[36:39], s62 offen offset:2560 sc1
  ds_write_b128 v5, v[156:159] offset:2592
  v_cvt_pk_bf16_f32 v12, v48, v49
  v_cvt_pk_bf16_f32 v13, v50, v51
  v_cvt_pk_bf16_f32 v14, v52, v53
  v_cvt_pk_bf16_f32 v15, v54, v55
  s_waitcnt lgkmcnt(0)
  s_barrier
  v_mov_b32 v252, 1
  s_lshl_b32 s75, s57, 2
  s_add_u32 s75, s75, s79
  s_waitcnt vmcnt(0)
  s_mov_b64 exec, 1
  buffer_store_dword v252, off, s[36:39], s75 sc1
  s_mov_b64 exec, -1
  s_branch L_attn
L_loader:
  v_lshrrev_b32 v13, 3, v0
  v_lshlrev_b32 v13, 10, v13
  v_and_b32 v14, 7, v0
  v_lshrrev_b32 v15, 4, v0
  v_xor_b32 v14, v14, v15
  v_lshl_add_u32 v13, v14, 4, v13
  v_xor_b32 v14, 64, v13
  v_add_u32 v2, 0, v13
  v_add_u32 v3, 7168, v14
  v_add_u32 v4, 14336, v13
  v_add_u32 v5, 21504, v14
  v_add_u32 v6, 32768, v13
  v_add_u32 v7, 39936, v14
  v_add_u32 v8, 47104, v13
  v_add_u32 v9, 54272, v14
  s_lshl_b32 s70, s57, 18
  s_lshl_b32 s62, s60, 16
  s_add_u32 s70, s70, s62
  s_lshr_b32 s63, s58, 1
  s_add_u32 s63, s63, s57
  s_and_b32 s63, s63, 1
  s_mul_i32 s63, s63, 3
  s_add_u32 s63, s63, 4
  s_waitcnt lgkmcnt(0)
  s_lshr_b32 s64, s4, 7
  s_sub_u32 s59, s63, s64
  s_and_b32 s59, s59, 7
  s_mov_b32 s24, s4
  s_mov_b32 s25, s5
  s_mov_b32 s26, 0x200000
  s_mov_b32 s27, 0x20000
  s_add_u32 s74, s59, 0
  s_and_b32 s74, s74, 7
  s_lshl_b32 s71, s74, 7
  s_lshl_b32 s75, s60, 13
  s_add_u32 m0, s75, 32768
  s_add_u32 s71, s71, s70
  buffer_load_dwordx4 v2, s[24:27], s71 offen offset:0 lds
  buffer_load_dwordx4 v3, s[24:27], s71 offen offset:1024 lds
  buffer_load_dwordx4 v4, s[24:27], s71 offen offset:2048 lds
  buffer_load_dwordx4 v5, s[24:27], s71 offen offset:3072 lds
  s_add_u32 m0, s75, 36864
  s_nop 0
  buffer_load_dwordx4 v6, s[24:27], s71 offen offset:0 lds
  buffer_load_dwordx4 v7, s[24:27], s71 offen offset:1024 lds
  buffer_load_dwordx4 v8, s[24:27], s71 offen offset:2048 lds
  buffer_load_dwordx4 v9, s[24:27], s71 offen offset:3072 lds
  s_cmp_lt_u32 s58, 16
  s_cselect_b32 s28, s6, s12
  s_cselect_b32 s29, s7, s13
  s_mov_b32 s30, 0x180000
  s_mov_b32 s31, 0x20000
  s_and_b32 s72, s58, 15
  s_lshl_b32 s72, s72, 6
  s_mul_i32 s62, s60, 49152
  s_add_u32 s72, s72, s62
  v_lshrrev_b32 v13, 2, v0
  v_mul_u32_u24 v13, 3072, v13
  v_and_b32 v14, 3, v0
  v_lshl_add_u32 v10, v14, 4, v13
  v_xor_b32 v11, 32, v10
  s_mul_i32 s75, s60, 3072
  s_mul_i32 s73, s74, 196608
  s_add_u32 m0, s75, 98304
  s_add_u32 s73, s73, s72
  buffer_load_dwordx4 v10, s[28:31], s73 offen offset:0 lds
  buffer_load_dwordx4 v11, s[28:31], s73 offen offset:1024 lds
  buffer_load_dwordx4 v10, s[28:31], s73 offen offset:2048 lds
  s_add_u32 s74, s59, 1
  s_and_b32 s74, s74, 7
  s_lshl_b32 s71, s74, 7
  s_lshl_b32 s75, s60, 13
  s_add_u32 m0, s75, 0
  s_add_u32 s71, s71, s70
  buffer_load_dwordx4 v2, s[24:27], s71 offen offset:0 lds
  buffer_load_dwordx4 v3, s[24:27], s71 offen offset:1024 lds
  buffer_load_dwordx4 v4, s[24:27], s71 offen offset:2048 lds
  buffer_load_dwordx4 v5, s[24:27], s71 offen offset:3072 lds
  s_add_u32 m0, s75, 4096
  s_nop 0
  buffer_load_dwordx4 v6, s[24:27], s71 offen offset:0 lds
  buffer_load_dwordx4 v7, s[24:27], s71 offen offset:1024 lds
  buffer_load_dwordx4 v8, s[24:27], s71 offen offset:2048 lds
  buffer_load_dwordx4 v9, s[24:27], s71 offen offset:3072 lds
  s_mul_i32 s75, s60, 3072
  s_mul_i32 s73, s74, 196608
  s_add_u32 m0, s75, 110592
  s_add_u32 s73, s73, s72
  buffer_load_dwordx4 v10, s[28:31], s73 offen offset:0 lds
  buffer_load_dwordx4 v11, s[28:31], s73 offen offset:1024 lds
  buffer_load_dwordx4 v10, s[28:31], s73 offen offset:2048 lds
  s_mov_b32 s36, s22
  s_mov_b32 s37, s23
  s_mov_b32 s38, 0x1800000
  s_mov_b32 s39, 0x20000
  s_mov_b32 s40, s8
  s_mov_b32 s41, s9
  s_mov_b32 s42, 0x80000
  s_mov_b32 s43, 0x20000
  s_mov_b32 s44, s14
  s_mov_b32 s45, s15
  s_mov_b32 s46, 0x80000
  s_mov_b32 s47, 0x20000
  s_mov_b32 s48, s18
  s_mov_b32 s49, s19
  s_mov_b32 s50, 0x200000
  s_mov_b32 s51, 0x20000
  s_mov_b32 s52, s20
  s_mov_b32 s53, s21
  s_mov_b32 s54, 0x100
  s_mov_b32 s55, 0x20000
  s_bfe_u32 s76, s2, 0x20001
  s_andn2_b32 s77, 1, s2
  s_lshl_b32 s77, s77, 2
  s_add_u32 s76, s76, s77
  s_bfe_u32 s77, s2, 0x20003
  s_lshr_b32 s78, s2, 5
  s_lshl_b32 s79, s58, 2
  s_add_u32 s79, s79, s60
  s_lshl_b32 s79, s79, 7
  s_add_u32 s79, s79, 12582912
  s_lshl_b32 s62, s57, 2
  s_add_u32 s62, s62, s60
  s_lshl_b32 s62, s62, 17
  s_lshl_b32 s63, s58, 1
  s_lshr_b32 s64, s56, 2
  s_add_u32 s63, s63, s64
  s_lshl_b32 s63, s63, 10
  s_add_u32 s62, s62, s63
  s_add_u32 s4, s62, 8388608
  s_lshl_b32 s62, s76, 3
  s_lshl_b32 s63, s77, 1
  s_add_u32 s62, s62, s63
  s_and_b32 s63, s56, 1
  s_add_u32 s62, s62, s63
  s_lshl_b32 s62, s62, 16
  s_lshr_b32 s63, s56, 1
  s_lshl_b32 s63, s63, 15
  s_add_u32 s62, s62, s63
  s_add_u32 s5, s62, 8388608
  s_lshl_b32 s62, s76, 8
  s_lshl_b32 s63, s77, 6
  s_add_u32 s62, s62, s63
  s_lshl_b32 s62, s62, 10
  s_lshl_b32 s63, s78, 7
  s_add_u32 s6, s62, s63
  s_lshr_b32 s7, s58, 4
  s_lshl_b32 s13, s7, 7
  s_and_b32 s62, s58, 15
  s_lshl_b32 s62, s62, 2
  s_add_u32 s13, s13, s62
  s_add_u32 s13, s13, 8
  s_mul_i32 s7, s7, 0x3f800000
  v_lshlrev_b32 v246, 4, v0
  s_lshr_b32 s62, s56, 2
  s_mul_i32 s62, s62, 16640
  v_add_u32 v240, s62, v246
  v_lshrrev_b32 v104, 5, v0
  v_and_b32 v105, 15, v0
  v_lshlrev_b32 v105, 4, v105
  v_lshl_add_u32 v105, v104, 8, v105
  v_add_u32 v105, 1024, v105
  v_add_u32 v106, 512, v105
  v_and_b32 v104, 11, v0
  v_cmp_eq_u32 vcc, 0, v104
  v_mov_b32 v107, 2064
  v_mov_b32 v108, 2048
  v_cndmask_b32 v107, v107, v108, vcc
  v_and_b32 v104, 16, v0
  v_cmp_eq_u32 vcc, 0, v104
  s_nop 1
  v_cndmask_b32 v105, v107, v105, vcc
  v_cndmask_b32 v106, v107, v106, vcc
  v_add_u32 v241, s62, v105
  v_add_u32 v242, s62, v106
  v_add_u32 v243, 130560, v240
  v_add_u32 v244, 130560, v241
  v_add_u32 v245, 130560, v242
  v_lshrrev_b32 v104, 3, v0
  v_lshlrev_b32 v104, 10, v104
  v_and_b32 v105, 7, v0
  v_lshlrev_b32 v248, 2, v105
  v_bfe_u32 v106, v0, 4, 1
  v_lshlrev_b32 v106, 2, v106
  v_xor_b32 v105, v105, v106
  v_lshl_add_u32 v247, v105, 4, v104
  v_and_b32 v253, 31, v0
  v_lshlrev_b32 v253, 2, v253
  s_lshl_b32 s3, s57, 10
  s_lshl_b32 s63, s60, 8
  s_add_u32 s3, s3, s63
  s_add_u32 s3, s3, 12615680
  v_mov_b32 v232, -1
  v_mov_b32 v233, -1
  v_mov_b32 v234, -1
  v_mov_b32 v235, -1
  v_mov_b32 v236, 0
  v_mov_b32 v237, 0
  v_mov_b32 v238, 0
  v_mov_b32 v239, 0
  v_mov_b32 v231, 0xdddd
  v_and_b32 v230, 0x33, v0
  v_bfe_u32 v254, v0, 2, 1
  v_lshl_or_b32 v230, v254, 3, v230
  v_bfe_u32 v254, v0, 3, 1
  v_lshl_or_b32 v230, v254, 2, v230
  v_lshlrev_b32 v230, 4, v230
  v_and_b32 v254, 1, v0
  v_lshlrev_b32 v254, 7, v254
  v_mov_b32 v255, 128
  v_mov_b32 v252, 1
  s_waitcnt vmcnt(11)
  s_barrier
  s_add_u32 s74, s59, 2
  s_and_b32 s74, s74, 7
  s_lshl_b32 s71, s74, 7
  s_lshl_b32 s75, s60, 13
  s_add_u32 m0, s75, 65536
  s_add_u32 s71, s71, s70
  buffer_load_dwordx4 v2, s[24:27], s71 offen offset:0 lds
  buffer_load_dwordx4 v3, s[24:27], s71 offen offset:1024 lds
  buffer_load_dwordx4 v4, s[24:27], s71 offen offset:2048 lds
  buffer_load_dwordx4 v5, s[24:27], s71 offen offset:3072 lds
  s_add_u32 m0, s75, 69632
  s_nop 0
  buffer_load_dwordx4 v6, s[24:27], s71 offen offset:0 lds
  buffer_load_dwordx4 v7, s[24:27], s71 offen offset:1024 lds
  buffer_load_dwordx4 v8, s[24:27], s71 offen offset:2048 lds
  buffer_load_dwordx4 v9, s[24:27], s71 offen offset:3072 lds
  s_mul_i32 s75, s60, 3072
  s_mul_i32 s73, s74, 196608
  s_add_u32 m0, s75, 122880
  s_add_u32 s73, s73, s72
  buffer_load_dwordx4 v10, s[28:31], s73 offen offset:0 lds
  buffer_load_dwordx4 v11, s[28:31], s73 offen offset:1024 lds
  buffer_load_dwordx4 v10, s[28:31], s73 offen offset:2048 lds
  s_waitcnt vmcnt(11)
  s_barrier
  s_add_u32 s74, s59, 3
  s_and_b32 s74, s74, 7
  s_lshl_b32 s71, s74, 7
  s_lshl_b32 s75, s60, 13
  s_add_u32 m0, s75, 32768
  s_add_u32 s71, s71, s70
  buffer_load_dwordx4 v2, s[24:27], s71 offen offset:0 lds
  buffer_load_dwordx4 v3, s[24:27], s71 offen offset:1024 lds
  buffer_load_dwordx4 v4, s[24:27], s71 offen offset:2048 lds
  buffer_load_dwordx4 v5, s[24:27], s71 offen offset:3072 lds
  s_add_u32 m0, s75, 36864
  s_nop 0
  buffer_load_dwordx4 v6, s[24:27], s71 offen offset:0 lds
  buffer_load_dwordx4 v7, s[24:27], s71 offen offset:1024 lds
  buffer_load_dwordx4 v8, s[24:27], s71 offen offset:2048 lds
  buffer_load_dwordx4 v9, s[24:27], s71 offen offset:3072 lds
  s_mul_i32 s75, s60, 3072
  s_mul_i32 s73, s74, 196608
  s_add_u32 m0, s75, 98304
  s_add_u32 s73, s73, s72
  buffer_load_dwordx4 v10, s[28:31], s73 offen offset:0 lds
  buffer_load_dwordx4 v11, s[28:31], s73 offen offset:1024 lds
  buffer_load_dwordx4 v10, s[28:31], s73 offen offset:2048 lds
  s_waitcnt vmcnt(11)
  s_barrier
  s_add_u32 s74, s59, 4
  s_and_b32 s74, s74, 7
  s_lshl_b32 s71, s74, 7
  s_lshl_b32 s75, s60, 13
  s_add_u32 m0, s75, 0
  s_add_u32 s71, s71, s70
  buffer_load_dwordx4 v2, s[24:27], s71 offen offset:0 lds
  buffer_load_dwordx4 v3, s[24:27], s71 offen offset:1024 lds
  buffer_load_dwordx4 v4, s[24:27], s71 offen offset:2048 lds
  buffer_load_dwordx4 v5, s[24:27], s71 offen offset:3072 lds
  s_add_u32 m0, s75, 4096
  s_nop 0
  buffer_load_dwordx4 v6, s[24:27], s71 offen offset:0 lds
  buffer_load_dwordx4 v7, s[24:27], s71 offen offset:1024 lds
  buffer_load_dwordx4 v8, s[24:27], s71 offen offset:2048 lds
  buffer_load_dwordx4 v9, s[24:27], s71 offen offset:3072 lds
  s_mul_i32 s75, s60, 3072
  s_mul_i32 s73, s74, 196608
  s_add_u32 m0, s75, 110592
  s_add_u32 s73, s73, s72
  buffer_load_dwordx4 v10, s[28:31], s73 offen offset:0 lds
  buffer_load_dwordx4 v11, s[28:31], s73 offen offset:1024 lds
  buffer_load_dwordx4 v10, s[28:31], s73 offen offset:2048 lds
  s_waitcnt vmcnt(11)
  s_barrier
  s_add_u32 s74, s59, 5
  s_and_b32 s74, s74, 7
  s_lshl_b32 s71, s74, 7
  s_lshl_b32 s75, s60, 13
  s_add_u32 m0, s75, 65536
  s_add_u32 s71, s71, s70
  buffer_load_dwordx4 v2, s[24:27], s71 offen offset:0 lds
  buffer_load_dwordx4 v3, s[24:27], s71 offen offset:1024 lds
  buffer_load_dwordx4 v4, s[24:27], s71 offen offset:2048 lds
  buffer_load_dwordx4 v5, s[24:27], s71 offen offset:3072 lds
  s_add_u32 m0, s75, 69632
  s_nop 0
  buffer_load_dwordx4 v6, s[24:27], s71 offen offset:0 lds
  buffer_load_dwordx4 v7, s[24:27], s71 offen offset:1024 lds
  buffer_load_dwordx4 v8, s[24:27], s71 offen offset:2048 lds
  buffer_load_dwordx4 v9, s[24:27], s71 offen offset:3072 lds
  s_mul_i32 s75, s60, 3072
  s_mul_i32 s73, s74, 196608
  s_add_u32 m0, s75, 122880
  s_add_u32 s73, s73, s72
  buffer_load_dwordx4 v10, s[28:31], s73 offen offset:0 lds
  buffer_load_dwordx4 v11, s[28:31], s73 offen offset:1024 lds
  buffer_load_dwordx4 v10, s[28:31], s73 offen offset:2048 lds
  s_waitcnt vmcnt(11)
  s_barrier
  s_add_u32 s74, s59, 6
  s_and_b32 s74, s74, 7
  s_lshl_b32 s71, s74, 7
  s_lshl_b32 s75, s60, 13
  s_add_u32 m0, s75, 32768
  s_add_u32 s71, s71, s70
  buffer_load_dwordx4 v2, s[24:27], s71 offen offset:0 lds
  buffer_load_dwordx4 v3, s[24:27], s71 offen offset:1024 lds
  buffer_load_dwordx4 v4, s[24:27], s71 offen offset:2048 lds
  buffer_load_dwordx4 v5, s[24:27], s71 offen offset:3072 lds
  s_add_u32 m0, s75, 36864
  s_nop 0
  buffer_load_dwordx4 v6, s[24:27], s71 offen offset:0 lds
  buffer_load_dwordx4 v7, s[24:27], s71 offen offset:1024 lds
  buffer_load_dwordx4 v8, s[24:27], s71 offen offset:2048 lds
  buffer_load_dwordx4 v9, s[24:27], s71 offen offset:3072 lds
  s_mul_i32 s75, s60, 3072
  s_mul_i32 s73, s74, 196608
  s_add_u32 m0, s75, 98304
  s_add_u32 s73, s73, s72
  buffer_load_dwordx4 v10, s[28:31], s73 offen offset:0 lds
  buffer_load_dwordx4 v11, s[28:31], s73 offen offset:1024 lds
  buffer_load_dwordx4 v10, s[28:31], s73 offen offset:2048 lds
  s_waitcnt vmcnt(11)
  s_barrier
  s_add_u32 s74, s59, 7
  s_and_b32 s74, s74, 7
  s_lshl_b32 s71, s74, 7
  s_lshl_b32 s75, s60, 13
  s_add_u32 m0, s75, 0
  s_add_u32 s71, s71, s70
  buffer_load_dwordx4 v2, s[24:27], s71 offen offset:0 lds
  buffer_load_dwordx4 v3, s[24:27], s71 offen offset:1024 lds
  buffer_load_dwordx4 v4, s[24:27], s71 offen offset:2048 lds
  buffer_load_dwordx4 v5, s[24:27], s71 offen offset:3072 lds
  s_add_u32 m0, s75, 4096
  s_nop 0
  buffer_load_dwordx4 v6, s[24:27], s71 offen offset:0 lds
  buffer_load_dwordx4 v7, s[24:27], s71 offen offset:1024 lds
  buffer_load_dwordx4 v8, s[24:27], s71 offen offset:2048 lds
  buffer_load_dwordx4 v9, s[24:27], s71 offen offset:3072 lds
  s_mul_i32 s75, s60, 3072
  s_mul_i32 s73, s74, 196608
  s_add_u32 m0, s75, 110592
  s_add_u32 s73, s73, s72
  buffer_load_dwordx4 v10, s[28:31], s73 offen offset:0 lds
  buffer_load_dwordx4 v11, s[28:31], s73 offen offset:1024 lds
  buffer_load_dwordx4 v10, s[28:31], s73 offen offset:2048 lds
  s_waitcnt vmcnt(11)
  s_barrier
  s_waitcnt vmcnt(0)
  s_barrier
  s_cmp_lg_u32 s56, 4
  s_cbranch_scc1 L_noz2
  buffer_load_dword v252, off, s[52:55], s13 sc1
L_noz2:
  s_lshl_b32 s70, s58, 18
  s_lshl_b32 s63, s56, 12
  s_add_u32 s70, s70, s63
  s_mul_i32 s72, s56, 4160
  s_lshl_b32 s73, s56, 13
  s_lshl_b32 s63, s78, 7
  s_add_u32 s73, s73, s63
  s_lshl_b32 s74, s56, 10
  s_andn2_b32 s63, 4, s57
  s_lshl_b32 s63, s63, 15
  s_add_u32 s12, s70, s63
  v_lshrrev_b32 v104, 4, v0
  v_mul_u32_u24 v104, 97280, v104
  v_and_b32 v105, 15, v0
  v_mul_u32_u24 v105, 2080, v105
  v_add_u32 v104, v104, v105
  v_add_u32 v104, 33280, v104
  v_mov_b32 v108, 0x3f803f80
  v_mov_b32 v112, 0
  v_mov_b32 v109, 0x3f803f80
  v_mov_b32 v113, 0
  v_mov_b32 v110, 0x3f803f80
  v_mov_b32 v114, 0
  v_mov_b32 v111, 0x3f803f80
  v_mov_b32 v115, 0
  s_mov_b32 exec_lo, 0xffffffff
  s_mov_b32 exec_hi, 0x0
  ds_write_b128 v104, v[108:111] offset:2048
  ds_write_b128 v104, v[112:115] offset:2064
  s_mov_b64 exec, -1
  s_cmp_lg_u32 s56, 4
  s_cbranch_scc1 L_noz3
  s_waitcnt vmcnt(0)
  v_cmp_gt_u32 vcc, 8, v252
  s_nop 0
  s_cbranch_vccnz L_spin_z
L_ret_z:
L_noz3:
  v_add_u32 v104, 4294934016, v104
  s_waitcnt lgkmcnt(0)
  s_lshl_b32 s64, s60, 11
  s_add_u32 s64, s64, 69632
  v_add_u32 v4, s64, v246
  s_barrier
  ds_read_b128 v[8:11], v4
  ds_read_b128 v[12:15], v4 offset:1024
  s_mov_b64 exec, 0xffff
  ds_write_b128 v104, v[108:111] offset:2048
  ds_write_b128 v104, v[112:115] offset:2064
  s_mov_b64 exec, -1
L_attn:
  ds_read_b128 v[16:19], v240 offset:33280
  ds_read_b128 v[20:23], v241 offset:33280
  s_waitcnt lgkmcnt(1)
  s_setprio 3
  v_mfma_f32_32x32x16_bf16 v[32:47], v[16:19], v[8:11], 0.15915494
  v_mfma_f32_32x32x16_bf16 v[64:79], v[236:239], v[236:239], 0
  v_mfma_f32_32x32x16_bf16 v[80:95], v[236:239], v[236:239], 0
  s_nop 7
  s_nop 1
  v_exp_f32 v32, v32
  v_exp_f32 v33, v33
  ds_read_b128 v[24:27], v242 offset:33280
  v_exp_f32 v34, v34
  v_exp_f32 v35, v35
  v_exp_f32 v36, v36
  v_mfma_f32_32x32x16_bf16 v[48:63], v[16:19], v[12:15], 0.15915494
  s_waitcnt lgkmcnt(1)
  ds_read_b128 v[16:19], v240 offset:35360
  v_exp_f32 v37, v37
  v_exp_f32 v38, v38
  v_exp_f32 v39, v39
  v_exp_f32 v40, v40
  v_exp_f32 v41, v41
  v_smfmac_f32_32x32x32_bf16 v[64:79], v[20:23], v[32:39], v231
  s_waitcnt lgkmcnt(1)
  v_exp_f32 v42, v42
  v_exp_f32 v43, v43
  v_exp_f32 v44, v44
  v_exp_f32 v45, v45
  v_exp_f32 v46, v46
  v_exp_f32 v47, v47
  v_exp_f32 v48, v48
  v_exp_f32 v49, v49
  v_smfmac_f32_32x32x32_bf16 v[64:79], v[24:27], v[40:47], v231
  s_waitcnt lgkmcnt(0)
  v_exp_f32 v50, v50
  v_exp_f32 v51, v51
  v_exp_f32 v52, v52
  v_mfma_f32_32x32x16_bf16 v[32:47], v[16:19], v[8:11], 0.15915494
  v_exp_f32 v53, v53
  v_exp_f32 v54, v54
  v_exp_f32 v55, v55
  v_exp_f32 v56, v56
  v_exp_f32 v57, v57
  v_smfmac_f32_32x32x32_bf16 v[80:95], v[20:23], v[48:55], v231
  ds_read_b128 v[20:23], v241 offset:35360
  v_exp_f32 v58, v58
  v_exp_f32 v59, v59
  v_exp_f32 v60, v60
  v_exp_f32 v61, v61
  v_exp_f32 v62, v62
  v_exp_f32 v63, v63
  v_exp_f32 v32, v32
  v_exp_f32 v33, v33
  v_smfmac_f32_32x32x32_bf16 v[80:95], v[24:27], v[56:63], v231
  ds_read_b128 v[24:27], v242 offset:35360
  v_exp_f32 v34, v34
  v_exp_f32 v35, v35
  v_exp_f32 v36, v36
  v_mfma_f32_32x32x16_bf16 v[48:63], v[16:19], v[12:15], 0.15915494
  s_waitcnt lgkmcnt(1)
  ds_read_b128 v[16:19], v240 offset:37440
  v_exp_f32 v37, v37
  v_exp_f32 v38, v38
  v_exp_f32 v39, v39
  v_exp_f32 v40, v40
  v_exp_f32 v41, v41
  v_smfmac_f32_32x32x32_bf16 v[64:79], v[20:23], v[32:39], v231
  s_waitcnt lgkmcnt(1)
  v_exp_f32 v42, v42
  v_exp_f32 v43, v43
  v_exp_f32 v44, v44
  v_exp_f32 v45, v45
  v_exp_f32 v46, v46
  v_exp_f32 v47, v47
  v_exp_f32 v48, v48
  v_exp_f32 v49, v49
  v_smfmac_f32_32x32x32_bf16 v[64:79], v[24:27], v[40:47], v231
  s_waitcnt lgkmcnt(0)
  v_exp_f32 v50, v50
  v_exp_f32 v51, v51
  v_exp_f32 v52, v52
  v_mfma_f32_32x32x16_bf16 v[32:47], v[16:19], v[8:11], 0.15915494
  s_setprio 2
  v_exp_f32 v53, v53
  v_exp_f32 v54, v54
  v_exp_f32 v55, v55
  v_exp_f32 v56, v56
  v_exp_f32 v57, v57
  v_smfmac_f32_32x32x32_bf16 v[80:95], v[20:23], v[48:55], v231
  ds_read_b128 v[20:23], v241 offset:37440
  v_exp_f32 v58, v58
  v_exp_f32 v59, v59
  v_exp_f32 v60, v60
  v_exp_f32 v61, v61
  v_exp_f32 v62, v62
  v_exp_f32 v63, v63
  v_exp_f32 v32, v32
  v_exp_f32 v33, v33
  v_smfmac_f32_32x32x32_bf16 v[80:95], v[24:27], v[56:63], v231
  ds_read_b128 v[24:27], v242 offset:37440
  v_exp_f32 v34, v34
  v_exp_f32 v35, v35
  v_exp_f32 v36, v36
  v_mfma_f32_32x32x16_bf16 v[48:63], v[16:19], v[12:15], 0.15915494
  s_waitcnt lgkmcnt(1)
  ds_read_b128 v[16:19], v240 offset:39520
  v_exp_f32 v37, v37
  v_exp_f32 v38, v38
  v_exp_f32 v39, v39
  v_exp_f32 v40, v40
  v_exp_f32 v41, v41
  v_smfmac_f32_32x32x32_bf16 v[64:79], v[20:23], v[32:39], v231
  s_waitcnt lgkmcnt(1)
  v_exp_f32 v42, v42
  v_exp_f32 v43, v43
  v_exp_f32 v44, v44
  v_exp_f32 v45, v45
  v_exp_f32 v46, v46
  v_exp_f32 v47, v47
  v_exp_f32 v48, v48
  v_exp_f32 v49, v49
  v_smfmac_f32_32x32x32_bf16 v[64:79], v[24:27], v[40:47], v231
  s_waitcnt lgkmcnt(0)
  v_exp_f32 v50, v50
  v_exp_f32 v51, v51
  v_exp_f32 v52, v52
  v_mfma_f32_32x32x16_bf16 v[32:47], v[16:19], v[8:11], 0.15915494
  s_cmp_lt_u32 s56, 4
  s_cbranch_scc1 L_nopoll
  buffer_load_dword v249, v248, s[36:39], s79 offen sc1
L_nopoll:
  v_exp_f32 v53, v53
  v_exp_f32 v54, v54
  v_exp_f32 v55, v55
  v_exp_f32 v56, v56
  v_exp_f32 v57, v57
  v_smfmac_f32_32x32x32_bf16 v[80:95], v[20:23], v[48:55], v231
  ds_read_b128 v[20:23], v241 offset:39520
  v_exp_f32 v58, v58
  v_exp_f32 v59, v59
  v_exp_f32 v60, v60
  v_exp_f32 v61, v61
  v_exp_f32 v62, v62
  v_exp_f32 v63, v63
  v_exp_f32 v32, v32
  v_exp_f32 v33, v33
  v_smfmac_f32_32x32x32_bf16 v[80:95], v[24:27], v[56:63], v231
  ds_read_b128 v[24:27], v242 offset:39520
  v_exp_f32 v34, v34
  v_exp_f32 v35, v35
  v_exp_f32 v36, v36
  v_mfma_f32_32x32x16_bf16 v[48:63], v[16:19], v[12:15], 0.15915494
  s_waitcnt lgkmcnt(1)
  ds_read_b128 v[16:19], v240 offset:41600
  v_exp_f32 v37, v37
  v_exp_f32 v38, v38
  v_exp_f32 v39, v39
  v_exp_f32 v40, v40
  v_exp_f32 v41, v41
  v_smfmac_f32_32x32x32_bf16 v[64:79], v[20:23], v[32:39], v231
  s_waitcnt lgkmcnt(1)
  v_exp_f32 v42, v42
  v_exp_f32 v43, v43
  v_exp_f32 v44, v44
  v_exp_f32 v45, v45
  v_exp_f32 v46, v46
  v_exp_f32 v47, v47
  v_exp_f32 v48, v48
  v_exp_f32 v49, v49
  v_smfmac_f32_32x32x32_bf16 v[64:79], v[24:27], v[40:47], v231
  s_waitcnt lgkmcnt(0)
  v_exp_f32 v50, v50
  v_exp_f32 v51, v51
  v_exp_f32 v52, v52
  v_mfma_f32_32x32x16_bf16 v[32:47], v[16:19], v[8:11], 0.15915494
  s_setprio 1
  s_cmp_lt_u32 s56, 4
  s_cbranch_scc1 L_skip_c1
  s_waitcnt vmcnt(0)
  v_cmp_ne_u32 vcc, 1, v249
  s_nop 0
  s_cbranch_vccnz L_spin_f1
L_ret_f1:
  s_add_u32 s71, s12, 0
  s_add_u32 m0, s72, 130560
  s_nop 0
  buffer_load_dwordx4 v246, s[36:39], s71 offen offset:0 sc1 lds
  buffer_load_dwordx4 v246, s[36:39], s71 offen offset:1024 sc1 lds
  s_add_u32 m0, s72, 130592
  s_nop 0
  buffer_load_dwordx4 v246, s[36:39], s71 offen offset:2048 sc1 lds
  buffer_load_dwordx4 v246, s[36:39], s71 offen offset:3072 sc1 lds
  s_sub_u32 s71, s71, 16384
  s_add_u32 m0, s72, 113920
  s_nop 0
  buffer_load_dwordx4 v246, s[36:39], s71 offen offset:0 sc1 lds
  buffer_load_dwordx4 v246, s[36:39], s71 offen offset:1024 sc1 lds
  s_add_u32 m0, s72, 113952
  s_nop 0
  buffer_load_dwordx4 v246, s[36:39], s71 offen offset:2048 sc1 lds
  buffer_load_dwordx4 v246, s[36:39], s71 offen offset:3072 sc1 lds
L_skip_c1:
  v_exp_f32 v53, v53
  v_exp_f32 v54, v54
  v_exp_f32 v55, v55
  v_exp_f32 v56, v56
  v_exp_f32 v57, v57
  v_smfmac_f32_32x32x32_bf16 v[80:95], v[20:23], v[48:55], v231
  ds_read_b128 v[20:23], v241 offset:41600
  v_exp_f32 v58, v58
  v_exp_f32 v59, v59
  v_exp_f32 v60, v60
  v_exp_f32 v61, v61
  v_exp_f32 v62, v62
  v_exp_f32 v63, v63
  v_exp_f32 v32, v32
  v_exp_f32 v33, v33
  v_smfmac_f32_32x32x32_bf16 v[80:95], v[24:27], v[56:63], v231
  ds_read_b128 v[24:27], v242 offset:41600
  v_exp_f32 v34, v34
  v_exp_f32 v35, v35
  v_exp_f32 v36, v36
  v_mfma_f32_32x32x16_bf16 v[48:63], v[16:19], v[12:15], 0.15915494
  s_waitcnt lgkmcnt(1)
  ds_read_b128 v[16:19], v240 offset:43680
  v_exp_f32 v37, v37
  v_exp_f32 v38, v38
  v_exp_f32 v39, v39
  v_exp_f32 v40, v40
  v_exp_f32 v41, v41
  v_smfmac_f32_32x32x32_bf16 v[64:79], v[20:23], v[32:39], v231
  s_waitcnt lgkmcnt(1)
  v_exp_f32 v42, v42
  v_exp_f32 v43, v43
  v_exp_f32 v44, v44
  v_exp_f32 v45, v45
  v_exp_f32 v46, v46
  v_exp_f32 v47, v47
  v_exp_f32 v48, v48
  v_exp_f32 v49, v49
  v_smfmac_f32_32x32x32_bf16 v[64:79], v[24:27], v[40:47], v231
  s_waitcnt lgkmcnt(0)
  v_exp_f32 v50, v50
  v_exp_f32 v51, v51
  v_exp_f32 v52, v52
  v_mfma_f32_32x32x16_bf16 v[32:47], v[16:19], v[8:11], 0.15915494
  s_cmp_lt_u32 s56, 4
  s_cbranch_scc1 L_skip_c2
  s_add_u32 s71, s12, 32768
  s_add_u32 m0, s72, 0
  s_nop 0
  buffer_load_dwordx4 v246, s[36:39], s71 offen offset:0 sc1 lds
  buffer_load_dwordx4 v246, s[36:39], s71 offen offset:1024 sc1 lds
  s_add_u32 m0, s72, 32
  s_nop 0
  buffer_load_dwordx4 v246, s[36:39], s71 offen offset:2048 sc1 lds
  buffer_load_dwordx4 v246, s[36:39], s71 offen offset:3072 sc1 lds
  s_sub_u32 s71, s71, 16384
  s_add_u32 m0, s72, -16640
  s_nop 0
  buffer_load_dwordx4 v246, s[36:39], s71 offen offset:0 sc1 lds
  buffer_load_dwordx4 v246, s[36:39], s71 offen offset:1024 sc1 lds
  s_add_u32 m0, s72, -16608
  s_nop 0
  buffer_load_dwordx4 v246, s[36:39], s71 offen offset:2048 sc1 lds
  buffer_load_dwordx4 v246, s[36:39], s71 offen offset:3072 sc1 lds
L_skip_c2:
  v_exp_f32 v53, v53
  v_exp_f32 v54, v54
  v_exp_f32 v55, v55
  v_exp_f32 v56, v56
  v_exp_f32 v57, v57
  v_smfmac_f32_32x32x32_bf16 v[80:95], v[20:23], v[48:55], v231
  ds_read_b128 v[20:23], v241 offset:43680
  v_exp_f32 v58, v58
  v_exp_f32 v59, v59
  v_exp_f32 v60, v60
  v_exp_f32 v61, v61
  v_exp_f32 v62, v62
  v_exp_f32 v63, v63
  v_exp_f32 v32, v32
  v_exp_f32 v33, v33
  v_smfmac_f32_32x32x32_bf16 v[80:95], v[24:27], v[56:63], v231
  ds_read_b128 v[24:27], v242 offset:43680
  v_exp_f32 v34, v34
  v_exp_f32 v35, v35
  v_exp_f32 v36, v36
  v_mfma_f32_32x32x16_bf16 v[48:63], v[16:19], v[12:15], 0.15915494
  s_waitcnt lgkmcnt(1)
  ds_read_b128 v[16:19], v240 offset:45760
  v_exp_f32 v37, v37
  v_exp_f32 v38, v38
  v_exp_f32 v39, v39
  v_exp_f32 v40, v40
  v_exp_f32 v41, v41
  v_smfmac_f32_32x32x32_bf16 v[64:79], v[20:23], v[32:39], v231
  s_waitcnt lgkmcnt(1)
  v_exp_f32 v42, v42
  v_exp_f32 v43, v43
  v_exp_f32 v44, v44
  v_exp_f32 v45, v45
  v_exp_f32 v46, v46
  v_exp_f32 v47, v47
  v_exp_f32 v48, v48
  v_exp_f32 v49, v49
  v_smfmac_f32_32x32x32_bf16 v[64:79], v[24:27], v[40:47], v231
  s_waitcnt lgkmcnt(0)
  v_exp_f32 v50, v50
  v_exp_f32 v51, v51
  v_exp_f32 v52, v52
  v_mfma_f32_32x32x16_bf16 v[32:47], v[16:19], v[8:11], 0.15915494
  s_setprio 0
  v_exp_f32 v53, v53
  v_exp_f32 v54, v54
  v_exp_f32 v55, v55
  v_exp_f32 v56, v56
  v_exp_f32 v57, v57
  v_smfmac_f32_32x32x32_bf16 v[80:95], v[20:23], v[48:55], v231
  ds_read_b128 v[20:23], v241 offset:45760
  v_exp_f32 v58, v58
  v_exp_f32 v59, v59
  v_exp_f32 v60, v60
  v_exp_f32 v61, v61
  v_exp_f32 v62, v62
  v_exp_f32 v63, v63
  v_exp_f32 v32, v32
  v_exp_f32 v33, v33
  v_smfmac_f32_32x32x32_bf16 v[80:95], v[24:27], v[56:63], v231
  ds_read_b128 v[24:27], v242 offset:45760
  v_exp_f32 v34, v34
  v_exp_f32 v35, v35
  v_exp_f32 v36, v36
  v_mfma_f32_32x32x16_bf16 v[48:63], v[16:19], v[12:15], 0.15915494
  s_waitcnt lgkmcnt(1)
  ds_read_b128 v[16:19], v240 offset:47840
  v_exp_f32 v37, v37
  v_exp_f32 v38, v38
  v_exp_f32 v39, v39
  v_exp_f32 v40, v40
  v_exp_f32 v41, v41
  v_smfmac_f32_32x32x32_bf16 v[64:79], v[20:23], v[32:39], v231
  s_waitcnt lgkmcnt(1)
  v_exp_f32 v42, v42
  v_exp_f32 v43, v43
  v_exp_f32 v44, v44
  v_exp_f32 v45, v45
  v_exp_f32 v46, v46
  v_exp_f32 v47, v47
  v_exp_f32 v48, v48
  v_exp_f32 v49, v49
  v_smfmac_f32_32x32x32_bf16 v[64:79], v[24:27], v[40:47], v231
  s_waitcnt lgkmcnt(0)
  v_exp_f32 v50, v50
  v_exp_f32 v51, v51
  v_exp_f32 v52, v52
  v_mfma_f32_32x32x16_bf16 v[32:47], v[16:19], v[8:11], 0.15915494
  v_exp_f32 v53, v53
  v_exp_f32 v54, v54
  v_exp_f32 v55, v55
  v_exp_f32 v56, v56
  v_exp_f32 v57, v57
  v_smfmac_f32_32x32x32_bf16 v[80:95], v[20:23], v[48:55], v231
  ds_read_b128 v[20:23], v241 offset:47840
  v_exp_f32 v58, v58
  v_exp_f32 v59, v59
  v_exp_f32 v60, v60
  v_exp_f32 v61, v61
  v_exp_f32 v62, v62
  v_exp_f32 v63, v63
  v_exp_f32 v32, v32
  v_exp_f32 v33, v33
  v_smfmac_f32_32x32x32_bf16 v[80:95], v[24:27], v[56:63], v231
  ds_read_b128 v[24:27], v242 offset:47840
  v_exp_f32 v34, v34
  v_exp_f32 v35, v35
  v_exp_f32 v36, v36
  v_mfma_f32_32x32x16_bf16 v[48:63], v[16:19], v[12:15], 0.15915494
  s_waitcnt lgkmcnt(1)
  v_exp_f32 v37, v37
  v_exp_f32 v38, v38
  v_exp_f32 v39, v39
  v_exp_f32 v40, v40
  v_exp_f32 v41, v41
  v_smfmac_f32_32x32x32_bf16 v[64:79], v[20:23], v[32:39], v231
  s_waitcnt lgkmcnt(0)
  s_setprio 3
  s_waitcnt vmcnt(8)
  s_barrier
  ds_read_b128 v[16:19], v243 offset:0
  v_exp_f32 v42, v42
  v_exp_f32 v43, v43
  v_exp_f32 v44, v44
  v_exp_f32 v45, v45
  v_exp_f32 v46, v46
  v_exp_f32 v47, v47
  v_exp_f32 v48, v48
  v_exp_f32 v49, v49
  v_smfmac_f32_32x32x32_bf16 v[64:79], v[24:27], v[40:47], v231
  s_waitcnt lgkmcnt(0)
  v_exp_f32 v50, v50
  v_exp_f32 v51, v51
  v_exp_f32 v52, v52
  v_mfma_f32_32x32x16_bf16 v[32:47], v[16:19], v[8:11], 0.15915494
  v_exp_f32 v53, v53
  v_exp_f32 v54, v54
  v_exp_f32 v55, v55
  v_exp_f32 v56, v56
  v_exp_f32 v57, v57
  v_smfmac_f32_32x32x32_bf16 v[80:95], v[20:23], v[48:55], v231
  ds_read_b128 v[20:23], v244 offset:0
  v_exp_f32 v58, v58
  v_exp_f32 v59, v59
  v_exp_f32 v60, v60
  v_exp_f32 v61, v61
  v_exp_f32 v62, v62
  v_exp_f32 v63, v63
  v_exp_f32 v32, v32
  v_exp_f32 v33, v33
  v_smfmac_f32_32x32x32_bf16 v[80:95], v[24:27], v[56:63], v231
  ds_read_b128 v[24:27], v245 offset:0
  v_exp_f32 v34, v34
  v_exp_f32 v35, v35
  v_exp_f32 v36, v36
  v_mfma_f32_32x32x16_bf16 v[48:63], v[16:19], v[12:15], 0.15915494
  s_waitcnt lgkmcnt(1)
  ds_read_b128 v[16:19], v243 offset:2080
  v_exp_f32 v37, v37
  v_exp_f32 v38, v38
  v_exp_f32 v39, v39
  v_exp_f32 v40, v40
  v_exp_f32 v41, v41
  v_smfmac_f32_32x32x32_bf16 v[64:79], v[20:23], v[32:39], v231
  s_waitcnt lgkmcnt(1)
  v_exp_f32 v42, v42
  v_exp_f32 v43, v43
  v_exp_f32 v44, v44
  v_exp_f32 v45, v45
  v_exp_f32 v46, v46
  v_exp_f32 v47, v47
  v_exp_f32 v48, v48
  v_exp_f32 v49, v49
  v_smfmac_f32_32x32x32_bf16 v[64:79], v[24:27], v[40:47], v231
  s_waitcnt lgkmcnt(0)
  v_exp_f32 v50, v50
  v_exp_f32 v51, v51
  v_exp_f32 v52, v52
  v_mfma_f32_32x32x16_bf16 v[32:47], v[16:19], v[8:11], 0.15915494
  s_add_u32 s71, s12, 65536
  s_add_u32 m0, s72, 33280
  s_nop 0
  buffer_load_dwordx4 v246, s[36:39], s71 offen offset:0 sc1 lds
  v_exp_f32 v53, v53
  v_exp_f32 v54, v54
  v_exp_f32 v55, v55
  v_exp_f32 v56, v56
  v_exp_f32 v57, v57
  v_smfmac_f32_32x32x32_bf16 v[80:95], v[20:23], v[48:55], v231
  ds_read_b128 v[20:23], v244 offset:2080
  v_exp_f32 v58, v58
  v_exp_f32 v59, v59
  v_exp_f32 v60, v60
  v_exp_f32 v61, v61
  v_exp_f32 v62, v62
  v_exp_f32 v63, v63
  v_exp_f32 v32, v32
  v_exp_f32 v33, v33
  v_smfmac_f32_32x32x32_bf16 v[80:95], v[24:27], v[56:63], v231
  ds_read_b128 v[24:27], v245 offset:2080
  v_exp_f32 v34, v34
  v_exp_f32 v35, v35
  v_exp_f32 v36, v36
  v_mfma_f32_32x32x16_bf16 v[48:63], v[16:19], v[12:15], 0.15915494
  s_waitcnt lgkmcnt(1)
  ds_read_b128 v[16:19], v243 offset:4160
  v_exp_f32 v37, v37
  v_exp_f32 v38, v38
  v_exp_f32 v39, v39
  v_exp_f32 v40, v40
  v_exp_f32 v41, v41
  v_smfmac_f32_32x32x32_bf16 v[64:79], v[20:23], v[32:39], v231
  s_waitcnt lgkmcnt(1)
  v_exp_f32 v42, v42
  v_exp_f32 v43, v43
  v_exp_f32 v44, v44
  v_exp_f32 v45, v45
  v_exp_f32 v46, v46
  v_exp_f32 v47, v47
  v_exp_f32 v48, v48
  v_exp_f32 v49, v49
  v_smfmac_f32_32x32x32_bf16 v[64:79], v[24:27], v[40:47], v231
  s_waitcnt lgkmcnt(0)
  v_exp_f32 v50, v50
  v_exp_f32 v51, v51
  v_exp_f32 v52, v52
  v_mfma_f32_32x32x16_bf16 v[32:47], v[16:19], v[8:11], 0.15915494
  buffer_load_dwordx4 v246, s[36:39], s71 offen offset:1024 sc1 lds
  v_exp_f32 v53, v53
  v_exp_f32 v54, v54
  v_exp_f32 v55, v55
  v_exp_f32 v56, v56
  v_exp_f32 v57, v57
  v_smfmac_f32_32x32x32_bf16 v[80:95], v[20:23], v[48:55], v231
  ds_read_b128 v[20:23], v244 offset:4160
  v_exp_f32 v58, v58
  v_exp_f32 v59, v59
  v_exp_f32 v60, v60
  v_exp_f32 v61, v61
  v_exp_f32 v62, v62
  v_exp_f32 v63, v63
  v_exp_f32 v32, v32
  v_exp_f32 v33, v33
  v_smfmac_f32_32x32x32_bf16 v[80:95], v[24:27], v[56:63], v231
  ds_read_b128 v[24:27], v245 offset:4160
  v_exp_f32 v34, v34
  v_exp_f32 v35, v35
  v_exp_f32 v36, v36
  v_mfma_f32_32x32x16_bf16 v[48:63], v[16:19], v[12:15], 0.15915494
  s_waitcnt lgkmcnt(1)
  ds_read_b128 v[16:19], v243 offset:6240
  v_exp_f32 v37, v37
  v_exp_f32 v38, v38
  v_exp_f32 v39, v39
  v_exp_f32 v40, v40
  v_exp_f32 v41, v41
  v_smfmac_f32_32x32x32_bf16 v[64:79], v[20:23], v[32:39], v231
  s_waitcnt lgkmcnt(1)
  v_exp_f32 v42, v42
  v_exp_f32 v43, v43
  v_exp_f32 v44, v44
  v_exp_f32 v45, v45
  v_exp_f32 v46, v46
  v_exp_f32 v47, v47
  v_exp_f32 v48, v48
  v_exp_f32 v49, v49
  v_smfmac_f32_32x32x32_bf16 v[64:79], v[24:27], v[40:47], v231
  s_waitcnt lgkmcnt(0)
  v_exp_f32 v50, v50
  v_exp_f32 v51, v51
  v_exp_f32 v52, v52
  v_mfma_f32_32x32x16_bf16 v[32:47], v[16:19], v[8:11], 0.15915494
  s_add_u32 m0, s72, 33312
  s_nop 0
  buffer_load_dwordx4 v246, s[36:39], s71 offen offset:2048 sc1 lds
  v_exp_f32 v53, v53
  v_exp_f32 v54, v54
  v_exp_f32 v55, v55
  v_exp_f32 v56, v56
  v_exp_f32 v57, v57
  v_smfmac_f32_32x32x32_bf16 v[80:95], v[20:23], v[48:55], v231
  ds_read_b128 v[20:23], v244 offset:6240
  v_exp_f32 v58, v58
  v_exp_f32 v59, v59
  v_exp_f32 v60, v60
  v_exp_f32 v61, v61
  v_exp_f32 v62, v62
  v_exp_f32 v63, v63
  v_exp_f32 v32, v32
  v_exp_f32 v33, v33
  v_smfmac_f32_32x32x32_bf16 v[80:95], v[24:27], v[56:63], v231
  ds_read_b128 v[24:27], v245 offset:6240
  v_exp_f32 v34, v34
  v_exp_f32 v35, v35
  v_exp_f32 v36, v36
  v_mfma_f32_32x32x16_bf16 v[48:63], v[16:19], v[12:15], 0.15915494
  s_waitcnt lgkmcnt(1)
  ds_read_b128 v[16:19], v243 offset:8320
  v_exp_f32 v37, v37
  v_exp_f32 v38, v38
  v_exp_f32 v39, v39
  v_exp_f32 v40, v40
  v_exp_f32 v41, v41
  v_smfmac_f32_32x32x32_bf16 v[64:79], v[20:23], v[32:39], v231
  s_waitcnt lgkmcnt(1)
  v_exp_f32 v42, v42
  v_exp_f32 v43, v43
  v_exp_f32 v44, v44
  v_exp_f32 v45, v45
  v_exp_f32 v46, v46
  v_exp_f32 v47, v47
  v_exp_f32 v48, v48
  v_exp_f32 v49, v49
  v_smfmac_f32_32x32x32_bf16 v[64:79], v[24:27], v[40:47], v231
  s_waitcnt lgkmcnt(0)
  v_exp_f32 v50, v50
  v_exp_f32 v51, v51
  v_exp_f32 v52, v52
  v_mfma_f32_32x32x16_bf16 v[32:47], v[16:19], v[8:11], 0.15915494
  buffer_load_dwordx4 v246, s[36:39], s71 offen offset:3072 sc1 lds
  v_exp_f32 v53, v53
  v_exp_f32 v54, v54
  v_exp_f32 v55, v55
  v_exp_f32 v56, v56
  v_exp_f32 v57, v57
  v_smfmac_f32_32x32x32_bf16 v[80:95], v[20:23], v[48:55], v231
  ds_read_b128 v[20:23], v244 offset:8320
  v_exp_f32 v58, v58
  v_exp_f32 v59, v59
  v_exp_f32 v60, v60
  v_exp_f32 v61, v61
  v_exp_f32 v62, v62
  v_exp_f32 v63, v63
  v_exp_f32 v32, v32
  v_exp_f32 v33, v33
  v_smfmac_f32_32x32x32_bf16 v[80:95], v[24:27], v[56:63], v231
  ds_read_b128 v[24:27], v245 offset:8320
  v_exp_f32 v34, v34
  v_exp_f32 v35, v35
  v_exp_f32 v36, v36
  v_mfma_f32_32x32x16_bf16 v[48:63], v[16:19], v[12:15], 0.15915494
  s_waitcnt lgkmcnt(1)
  s_setprio 2
  ds_read_b128 v[16:19], v243 offset:10400
  v_exp_f32 v37, v37
  v_exp_f32 v38, v38
  v_exp_f32 v39, v39
  v_exp_f32 v40, v40
  v_exp_f32 v41, v41
  v_smfmac_f32_32x32x32_bf16 v[64:79], v[20:23], v[32:39], v231
  s_waitcnt lgkmcnt(1)
  v_exp_f32 v42, v42
  v_exp_f32 v43, v43
  v_exp_f32 v44, v44
  v_exp_f32 v45, v45
  v_exp_f32 v46, v46
  v_exp_f32 v47, v47
  v_exp_f32 v48, v48
  v_exp_f32 v49, v49
  v_smfmac_f32_32x32x32_bf16 v[64:79], v[24:27], v[40:47], v231
  s_waitcnt lgkmcnt(0)
  v_exp_f32 v50, v50
  v_exp_f32 v51, v51
  v_exp_f32 v52, v52
  v_mfma_f32_32x32x16_bf16 v[32:47], v[16:19], v[8:11], 0.15915494
  s_add_u32 m0, s74, 73728
  s_add_u32 s75, s73, 65536
  buffer_load_dwordx4 v247, s[44:47], s75 offen lds
  v_exp_f32 v53, v53
  v_exp_f32 v54, v54
  v_exp_f32 v55, v55
  v_exp_f32 v56, v56
  v_exp_f32 v57, v57
  v_smfmac_f32_32x32x32_bf16 v[80:95], v[20:23], v[48:55], v231
  ds_read_b128 v[20:23], v244 offset:10400
  v_exp_f32 v58, v58
  v_exp_f32 v59, v59
  v_exp_f32 v60, v60
  v_exp_f32 v61, v61
  v_exp_f32 v62, v62
  v_exp_f32 v63, v63
  v_exp_f32 v32, v32
  v_exp_f32 v33, v33
  v_smfmac_f32_32x32x32_bf16 v[80:95], v[24:27], v[56:63], v231
  ds_read_b128 v[24:27], v245 offset:10400
  v_exp_f32 v34, v34
  v_exp_f32 v35, v35
  v_exp_f32 v36, v36
  v_mfma_f32_32x32x16_bf16 v[48:63], v[16:19], v[12:15], 0.15915494
  s_waitcnt lgkmcnt(1)
  ds_read_b128 v[16:19], v243 offset:12480
  v_exp_f32 v37, v37
  v_exp_f32 v38, v38
  v_exp_f32 v39, v39
  v_exp_f32 v40, v40
  v_exp_f32 v41, v41
  v_smfmac_f32_32x32x32_bf16 v[64:79], v[20:23], v[32:39], v231
  s_waitcnt lgkmcnt(1)
  v_exp_f32 v42, v42
  v_exp_f32 v43, v43
  v_exp_f32 v44, v44
  v_exp_f32 v45, v45
  v_exp_f32 v46, v46
  v_exp_f32 v47, v47
  v_exp_f32 v48, v48
  v_exp_f32 v49, v49
  v_smfmac_f32_32x32x32_bf16 v[64:79], v[24:27], v[40:47], v231
  s_waitcnt lgkmcnt(0)
  v_exp_f32 v50, v50
  v_exp_f32 v51, v51
  v_exp_f32 v52, v52
  v_mfma_f32_32x32x16_bf16 v[32:47], v[16:19], v[8:11], 0.15915494
  s_setprio 1
  s_add_u32 m0, s74, 81920
  s_add_u32 s75, s73, 131072
  buffer_load_dwordx4 v247, s[44:47], s75 offen lds
  v_exp_f32 v53, v53
  v_exp_f32 v54, v54
  v_exp_f32 v55, v55
  v_exp_f32 v56, v56
  v_exp_f32 v57, v57
  v_smfmac_f32_32x32x32_bf16 v[80:95], v[20:23], v[48:55], v231
  ds_read_b128 v[20:23], v244 offset:12480
  v_exp_f32 v58, v58
  v_exp_f32 v59, v59
  v_exp_f32 v60, v60
  v_exp_f32 v61, v61
  v_exp_f32 v62, v62
  v_exp_f32 v63, v63
  v_exp_f32 v32, v32
  v_exp_f32 v33, v33
  v_smfmac_f32_32x32x32_bf16 v[80:95], v[24:27], v[56:63], v231
  ds_read_b128 v[24:27], v245 offset:12480
  v_exp_f32 v34, v34
  v_exp_f32 v35, v35
  v_exp_f32 v36, v36
  v_mfma_f32_32x32x16_bf16 v[48:63], v[16:19], v[12:15], 0.15915494
  s_waitcnt lgkmcnt(1)
  ds_read_b128 v[16:19], v243 offset:14560
  v_exp_f32 v37, v37
  v_exp_f32 v38, v38
  v_exp_f32 v39, v39
  v_exp_f32 v40, v40
  v_exp_f32 v41, v41
  v_smfmac_f32_32x32x32_bf16 v[64:79], v[20:23], v[32:39], v231
  s_waitcnt lgkmcnt(1)
  v_exp_f32 v42, v42
  v_exp_f32 v43, v43
  v_exp_f32 v44, v44
  v_exp_f32 v45, v45
  v_exp_f32 v46, v46
  v_exp_f32 v47, v47
  v_exp_f32 v48, v48
  v_exp_f32 v49, v49
  v_smfmac_f32_32x32x32_bf16 v[64:79], v[24:27], v[40:47], v231
  s_waitcnt lgkmcnt(0)
  v_exp_f32 v50, v50
  v_exp_f32 v51, v51
  v_exp_f32 v52, v52
  v_mfma_f32_32x32x16_bf16 v[32:47], v[16:19], v[8:11], 0.15915494
  s_setprio 0
  buffer_store_dwordx4 v[232:235], v246, s[36:39], s4 offen sc1
  s_add_u32 s75, s4, 65536
  buffer_store_dwordx4 v[232:235], v246, s[36:39], s75 offen sc1
  v_exp_f32 v53, v53
  v_exp_f32 v54, v54
  v_exp_f32 v55, v55
  v_exp_f32 v56, v56
  v_exp_f32 v57, v57
  v_smfmac_f32_32x32x32_bf16 v[80:95], v[20:23], v[48:55], v231
  ds_read_b128 v[20:23], v244 offset:14560
  v_exp_f32 v58, v58
  v_exp_f32 v59, v59
  v_exp_f32 v60, v60
  v_exp_f32 v61, v61
  v_exp_f32 v62, v62
  v_exp_f32 v63, v63
  v_exp_f32 v32, v32
  v_exp_f32 v33, v33
  v_smfmac_f32_32x32x32_bf16 v[80:95], v[24:27], v[56:63], v231
  ds_read_b128 v[24:27], v245 offset:14560
  v_exp_f32 v34, v34
  v_exp_f32 v35, v35
  v_exp_f32 v36, v36
  v_mfma_f32_32x32x16_bf16 v[48:63], v[16:19], v[12:15], 0.15915494
  s_waitcnt lgkmcnt(1)
  v_exp_f32 v37, v37
  v_exp_f32 v38, v38
  v_exp_f32 v39, v39
  v_exp_f32 v40, v40
  v_exp_f32 v41, v41
  v_smfmac_f32_32x32x32_bf16 v[64:79], v[20:23], v[32:39], v231
  s_waitcnt lgkmcnt(0)
  s_setprio 3
  s_waitcnt vmcnt(8)
  s_barrier
  ds_read_b128 v[16:19], v240 offset:0
  v_exp_f32 v42, v42
  v_exp_f32 v43, v43
  v_exp_f32 v44, v44
  v_exp_f32 v45, v45
  v_exp_f32 v46, v46
  v_exp_f32 v47, v47
  v_exp_f32 v48, v48
  v_exp_f32 v49, v49
  v_smfmac_f32_32x32x32_bf16 v[64:79], v[24:27], v[40:47], v231
  s_waitcnt lgkmcnt(0)
  v_exp_f32 v50, v50
  v_exp_f32 v51, v51
  v_exp_f32 v52, v52
  v_mfma_f32_32x32x16_bf16 v[32:47], v[16:19], v[8:11], 0.15915494
  v_exp_f32 v53, v53
  v_exp_f32 v54, v54
  v_exp_f32 v55, v55
  v_exp_f32 v56, v56
  v_exp_f32 v57, v57
  v_smfmac_f32_32x32x32_bf16 v[80:95], v[20:23], v[48:55], v231
  ds_read_b128 v[20:23], v241 offset:0
  v_exp_f32 v58, v58
  v_exp_f32 v59, v59
  v_exp_f32 v60, v60
  v_exp_f32 v61, v61
  v_exp_f32 v62, v62
  v_exp_f32 v63, v63
  v_exp_f32 v32, v32
  v_exp_f32 v33, v33
  v_smfmac_f32_32x32x32_bf16 v[80:95], v[24:27], v[56:63], v231
  ds_read_b128 v[24:27], v242 offset:0
  v_exp_f32 v34, v34
  v_exp_f32 v35, v35
  v_exp_f32 v36, v36
  v_mfma_f32_32x32x16_bf16 v[48:63], v[16:19], v[12:15], 0.15915494
  s_waitcnt lgkmcnt(1)
  ds_read_b128 v[16:19], v240 offset:2080
  v_exp_f32 v37, v37
  v_exp_f32 v38, v38
  v_exp_f32 v39, v39
  v_exp_f32 v40, v40
  v_exp_f32 v41, v41
  v_smfmac_f32_32x32x32_bf16 v[64:79], v[20:23], v[32:39], v231
  s_waitcnt lgkmcnt(1)
  v_exp_f32 v42, v42
  v_exp_f32 v43, v43
  v_exp_f32 v44, v44
  v_exp_f32 v45, v45
  v_exp_f32 v46, v46
  v_exp_f32 v47, v47
  v_exp_f32 v48, v48
  v_exp_f32 v49, v49
  v_smfmac_f32_32x32x32_bf16 v[64:79], v[24:27], v[40:47], v231
  s_waitcnt lgkmcnt(0)
  v_exp_f32 v50, v50
  v_exp_f32 v51, v51
  v_exp_f32 v52, v52
  v_mfma_f32_32x32x16_bf16 v[32:47], v[16:19], v[8:11], 0.15915494
  s_add_u32 s71, s12, 98304
  s_add_u32 m0, s72, 130560
  s_nop 0
  buffer_load_dwordx4 v246, s[36:39], s71 offen offset:0 sc1 lds
  v_exp_f32 v53, v53
  v_exp_f32 v54, v54
  v_exp_f32 v55, v55
  v_exp_f32 v56, v56
  v_exp_f32 v57, v57
  v_smfmac_f32_32x32x32_bf16 v[80:95], v[20:23], v[48:55], v231
  ds_read_b128 v[20:23], v241 offset:2080
  v_exp_f32 v58, v58
  v_exp_f32 v59, v59
  v_exp_f32 v60, v60
  v_exp_f32 v61, v61
  v_exp_f32 v62, v62
  v_exp_f32 v63, v63
  v_exp_f32 v32, v32
  v_exp_f32 v33, v33
  v_smfmac_f32_32x32x32_bf16 v[80:95], v[24:27], v[56:63], v231
  ds_read_b128 v[24:27], v242 offset:2080
  v_exp_f32 v34, v34
  v_exp_f32 v35, v35
  v_exp_f32 v36, v36
  v_mfma_f32_32x32x16_bf16 v[48:63], v[16:19], v[12:15], 0.15915494
  s_waitcnt lgkmcnt(1)
  ds_read_b128 v[16:19], v240 offset:4160
  v_exp_f32 v37, v37
  v_exp_f32 v38, v38
  v_exp_f32 v39, v39
  v_exp_f32 v40, v40
  v_exp_f32 v41, v41
  v_smfmac_f32_32x32x32_bf16 v[64:79], v[20:23], v[32:39], v231
  s_waitcnt lgkmcnt(1)
  v_exp_f32 v42, v42
  v_exp_f32 v43, v43
  v_exp_f32 v44, v44
  v_exp_f32 v45, v45
  v_exp_f32 v46, v46
  v_exp_f32 v47, v47
  v_exp_f32 v48, v48
  v_exp_f32 v49, v49
  v_smfmac_f32_32x32x32_bf16 v[64:79], v[24:27], v[40:47], v231
  s_waitcnt lgkmcnt(0)
  v_exp_f32 v50, v50
  v_exp_f32 v51, v51
  v_exp_f32 v52, v52
  v_mfma_f32_32x32x16_bf16 v[32:47], v[16:19], v[8:11], 0.15915494
  buffer_load_dwordx4 v246, s[36:39], s71 offen offset:1024 sc1 lds
  v_exp_f32 v53, v53
  v_exp_f32 v54, v54
  v_exp_f32 v55, v55
  v_exp_f32 v56, v56
  v_exp_f32 v57, v57
  v_smfmac_f32_32x32x32_bf16 v[80:95], v[20:23], v[48:55], v231
  ds_read_b128 v[20:23], v241 offset:4160
  v_exp_f32 v58, v58
  v_exp_f32 v59, v59
  v_exp_f32 v60, v60
  v_exp_f32 v61, v61
  v_exp_f32 v62, v62
  v_exp_f32 v63, v63
  v_exp_f32 v32, v32
  v_exp_f32 v33, v33
  v_smfmac_f32_32x32x32_bf16 v[80:95], v[24:27], v[56:63], v231
  ds_read_b128 v[24:27], v242 offset:4160
  v_exp_f32 v34, v34
  v_exp_f32 v35, v35
  v_exp_f32 v36, v36
  v_mfma_f32_32x32x16_bf16 v[48:63], v[16:19], v[12:15], 0.15915494
  s_waitcnt lgkmcnt(1)
  ds_read_b128 v[16:19], v240 offset:6240
  v_exp_f32 v37, v37
  v_exp_f32 v38, v38
  v_exp_f32 v39, v39
  v_exp_f32 v40, v40
  v_exp_f32 v41, v41
  v_smfmac_f32_32x32x32_bf16 v[64:79], v[20:23], v[32:39], v231
  s_waitcnt lgkmcnt(1)
  v_exp_f32 v42, v42
  v_exp_f32 v43, v43
  v_exp_f32 v44, v44
  v_exp_f32 v45, v45
  v_exp_f32 v46, v46
  v_exp_f32 v47, v47
  v_exp_f32 v48, v48
  v_exp_f32 v49, v49
  v_smfmac_f32_32x32x32_bf16 v[64:79], v[24:27], v[40:47], v231
  s_waitcnt lgkmcnt(0)
  v_exp_f32 v50, v50
  v_exp_f32 v51, v51
  v_exp_f32 v52, v52
  v_mfma_f32_32x32x16_bf16 v[32:47], v[16:19], v[8:11], 0.15915494
  s_add_u32 m0, s72, 130592
  s_nop 0
  buffer_load_dwordx4 v246, s[36:39], s71 offen offset:2048 sc1 lds
  v_exp_f32 v53, v53
  v_exp_f32 v54, v54
  v_exp_f32 v55, v55
  v_exp_f32 v56, v56
  v_exp_f32 v57, v57
  v_smfmac_f32_32x32x32_bf16 v[80:95], v[20:23], v[48:55], v231
  ds_read_b128 v[20:23], v241 offset:6240
  v_exp_f32 v58, v58
  v_exp_f32 v59, v59
  v_exp_f32 v60, v60
  v_exp_f32 v61, v61
  v_exp_f32 v62, v62
  v_exp_f32 v63, v63
  v_exp_f32 v32, v32
  v_exp_f32 v33, v33
  v_smfmac_f32_32x32x32_bf16 v[80:95], v[24:27], v[56:63], v231
  ds_read_b128 v[24:27], v242 offset:6240
  v_exp_f32 v34, v34
  v_exp_f32 v35, v35
  v_exp_f32 v36, v36
  v_mfma_f32_32x32x16_bf16 v[48:63], v[16:19], v[12:15], 0.15915494
  s_waitcnt lgkmcnt(1)
  ds_read_b128 v[16:19], v240 offset:8320
  v_exp_f32 v37, v37
  v_exp_f32 v38, v38
  v_exp_f32 v39, v39
  v_exp_f32 v40, v40
  v_exp_f32 v41, v41
  v_smfmac_f32_32x32x32_bf16 v[64:79], v[20:23], v[32:39], v231
  s_waitcnt lgkmcnt(1)
  v_exp_f32 v42, v42
  v_exp_f32 v43, v43
  v_exp_f32 v44, v44
  v_exp_f32 v45, v45
  v_exp_f32 v46, v46
  v_exp_f32 v47, v47
  v_exp_f32 v48, v48
  v_exp_f32 v49, v49
  v_smfmac_f32_32x32x32_bf16 v[64:79], v[24:27], v[40:47], v231
  s_waitcnt lgkmcnt(0)
  v_exp_f32 v50, v50
  v_exp_f32 v51, v51
  v_exp_f32 v52, v52
  v_mfma_f32_32x32x16_bf16 v[32:47], v[16:19], v[8:11], 0.15915494
  buffer_load_dwordx4 v246, s[36:39], s71 offen offset:3072 sc1 lds
  v_exp_f32 v53, v53
  v_exp_f32 v54, v54
  v_exp_f32 v55, v55
  v_exp_f32 v56, v56
  v_exp_f32 v57, v57
  v_smfmac_f32_32x32x32_bf16 v[80:95], v[20:23], v[48:55], v231
  ds_read_b128 v[20:23], v241 offset:8320
  v_exp_f32 v58, v58
  v_exp_f32 v59, v59
  v_exp_f32 v60, v60
  v_exp_f32 v61, v61
  v_exp_f32 v62, v62
  v_exp_f32 v63, v63
  v_exp_f32 v32, v32
  v_exp_f32 v33, v33
  v_smfmac_f32_32x32x32_bf16 v[80:95], v[24:27], v[56:63], v231
  ds_read_b128 v[24:27], v242 offset:8320
  v_exp_f32 v34, v34
  v_exp_f32 v35, v35
  v_exp_f32 v36, v36
  v_mfma_f32_32x32x16_bf16 v[48:63], v[16:19], v[12:15], 0.15915494
  s_waitcnt lgkmcnt(1)
  s_setprio 2
  ds_read_b128 v[16:19], v240 offset:10400
  v_exp_f32 v37, v37
  v_exp_f32 v38, v38
  v_exp_f32 v39, v39
  v_exp_f32 v40, v40
  v_exp_f32 v41, v41
  v_smfmac_f32_32x32x32_bf16 v[64:79], v[20:23], v[32:39], v231
  s_waitcnt lgkmcnt(1)
  v_exp_f32 v42, v42
  v_exp_f32 v43, v43
  v_exp_f32 v44, v44
  v_exp_f32 v45, v45
  v_exp_f32 v46, v46
  v_exp_f32 v47, v47
  v_exp_f32 v48, v48
  v_exp_f32 v49, v49
  v_smfmac_f32_32x32x32_bf16 v[64:79], v[24:27], v[40:47], v231
  s_waitcnt lgkmcnt(0)
  v_exp_f32 v50, v50
  v_exp_f32 v51, v51
  v_exp_f32 v52, v52
  v_mfma_f32_32x32x16_bf16 v[32:47], v[16:19], v[8:11], 0.15915494
  s_add_u32 m0, s74, 90112
  s_add_u32 s75, s73, 196608
  buffer_load_dwordx4 v247, s[44:47], s75 offen lds
  v_exp_f32 v53, v53
  v_exp_f32 v54, v54
  v_exp_f32 v55, v55
  v_exp_f32 v56, v56
  v_exp_f32 v57, v57
  v_smfmac_f32_32x32x32_bf16 v[80:95], v[20:23], v[48:55], v231
  ds_read_b128 v[20:23], v241 offset:10400
  v_exp_f32 v58, v58
  v_exp_f32 v59, v59
  v_exp_f32 v60, v60
  v_exp_f32 v61, v61
  v_exp_f32 v62, v62
  v_exp_f32 v63, v63
  v_exp_f32 v32, v32
  v_exp_f32 v33, v33
  v_smfmac_f32_32x32x32_bf16 v[80:95], v[24:27], v[56:63], v231
  ds_read_b128 v[24:27], v242 offset:10400
  v_exp_f32 v34, v34
  v_exp_f32 v35, v35
  v_exp_f32 v36, v36
  v_mfma_f32_32x32x16_bf16 v[48:63], v[16:19], v[12:15], 0.15915494
  s_waitcnt lgkmcnt(1)
  ds_read_b128 v[16:19], v240 offset:12480
  v_exp_f32 v37, v37
  v_exp_f32 v38, v38
  v_exp_f32 v39, v39
  v_exp_f32 v40, v40
  v_exp_f32 v41, v41
  v_smfmac_f32_32x32x32_bf16 v[64:79], v[20:23], v[32:39], v231
  s_waitcnt lgkmcnt(1)
  v_exp_f32 v42, v42
  v_exp_f32 v43, v43
  v_exp_f32 v44, v44
  v_exp_f32 v45, v45
  v_exp_f32 v46, v46
  v_exp_f32 v47, v47
  v_exp_f32 v48, v48
  v_exp_f32 v49, v49
  v_smfmac_f32_32x32x32_bf16 v[64:79], v[24:27], v[40:47], v231
  s_waitcnt lgkmcnt(0)
  v_exp_f32 v50, v50
  v_exp_f32 v51, v51
  v_exp_f32 v52, v52
  v_mfma_f32_32x32x16_bf16 v[32:47], v[16:19], v[8:11], 0.15915494
  s_setprio 1
  s_add_u32 m0, s74, 98304
  s_add_u32 s75, s73, 262144
  buffer_load_dwordx4 v247, s[44:47], s75 offen lds
  v_exp_f32 v53, v53
  v_exp_f32 v54, v54
  v_exp_f32 v55, v55
  v_exp_f32 v56, v56
  v_exp_f32 v57, v57
  v_smfmac_f32_32x32x32_bf16 v[80:95], v[20:23], v[48:55], v231
  ds_read_b128 v[20:23], v241 offset:12480
  v_exp_f32 v58, v58
  v_exp_f32 v59, v59
  v_exp_f32 v60, v60
  v_exp_f32 v61, v61
  v_exp_f32 v62, v62
  v_exp_f32 v63, v63
  v_exp_f32 v32, v32
  v_exp_f32 v33, v33
  v_smfmac_f32_32x32x32_bf16 v[80:95], v[24:27], v[56:63], v231
  ds_read_b128 v[24:27], v242 offset:12480
  v_exp_f32 v34, v34
  v_exp_f32 v35, v35
  v_exp_f32 v36, v36
  v_mfma_f32_32x32x16_bf16 v[48:63], v[16:19], v[12:15], 0.15915494
  s_waitcnt lgkmcnt(1)
  ds_read_b128 v[16:19], v240 offset:14560
  v_exp_f32 v37, v37
  v_exp_f32 v38, v38
  v_exp_f32 v39, v39
  v_exp_f32 v40, v40
  v_exp_f32 v41, v41
  v_smfmac_f32_32x32x32_bf16 v[64:79], v[20:23], v[32:39], v231
  s_waitcnt lgkmcnt(1)
  v_exp_f32 v42, v42
  v_exp_f32 v43, v43
  v_exp_f32 v44, v44
  v_exp_f32 v45, v45
  v_exp_f32 v46, v46
  v_exp_f32 v47, v47
  v_exp_f32 v48, v48
  v_exp_f32 v49, v49
  v_smfmac_f32_32x32x32_bf16 v[64:79], v[24:27], v[40:47], v231
  s_waitcnt lgkmcnt(0)
  v_exp_f32 v50, v50
  v_exp_f32 v51, v51
  v_exp_f32 v52, v52
  v_mfma_f32_32x32x16_bf16 v[32:47], v[16:19], v[8:11], 0.15915494
  s_setprio 0
  v_exp_f32 v53, v53
  v_exp_f32 v54, v54
  v_exp_f32 v55, v55
  v_exp_f32 v56, v56
  v_exp_f32 v57, v57
  v_smfmac_f32_32x32x32_bf16 v[80:95], v[20:23], v[48:55], v231
  ds_read_b128 v[20:23], v241 offset:14560
  v_exp_f32 v58, v58
  v_exp_f32 v59, v59
  v_exp_f32 v60, v60
  v_exp_f32 v61, v61
  v_exp_f32 v62, v62
  v_exp_f32 v63, v63
  v_exp_f32 v32, v32
  v_exp_f32 v33, v33
  v_smfmac_f32_32x32x32_bf16 v[80:95], v[24:27], v[56:63], v231
  ds_read_b128 v[24:27], v242 offset:14560
  v_exp_f32 v34, v34
  v_exp_f32 v35, v35
  v_exp_f32 v36, v36
  v_mfma_f32_32x32x16_bf16 v[48:63], v[16:19], v[12:15], 0.15915494
  s_waitcnt lgkmcnt(1)
  v_exp_f32 v37, v37
  v_exp_f32 v38, v38
  v_exp_f32 v39, v39
  v_exp_f32 v40, v40
  v_exp_f32 v41, v41
  v_smfmac_f32_32x32x32_bf16 v[64:79], v[20:23], v[32:39], v231
  s_waitcnt lgkmcnt(0)
  s_setprio 3
  s_waitcnt vmcnt(6)
  s_barrier
  ds_read_b128 v[16:19], v240 offset:33280
  v_exp_f32 v42, v42
  v_exp_f32 v43, v43
  v_exp_f32 v44, v44
  v_exp_f32 v45, v45
  v_exp_f32 v46, v46
  v_exp_f32 v47, v47
  v_exp_f32 v48, v48
  v_exp_f32 v49, v49
  v_smfmac_f32_32x32x32_bf16 v[64:79], v[24:27], v[40:47], v231
  s_waitcnt lgkmcnt(0)
  v_exp_f32 v50, v50
  v_exp_f32 v51, v51
  v_exp_f32 v52, v52
  v_mfma_f32_32x32x16_bf16 v[32:47], v[16:19], v[8:11], 0.15915494
  v_exp_f32 v53, v53
  v_exp_f32 v54, v54
  v_exp_f32 v55, v55
  v_exp_f32 v56, v56
  v_exp_f32 v57, v57
  v_smfmac_f32_32x32x32_bf16 v[80:95], v[20:23], v[48:55], v231
  ds_read_b128 v[20:23], v241 offset:33280
  v_exp_f32 v58, v58
  v_exp_f32 v59, v59
  v_exp_f32 v60, v60
  v_exp_f32 v61, v61
  v_exp_f32 v62, v62
  v_exp_f32 v63, v63
  v_exp_f32 v32, v32
  v_exp_f32 v33, v33
  v_smfmac_f32_32x32x32_bf16 v[80:95], v[24:27], v[56:63], v231
  ds_read_b128 v[24:27], v242 offset:33280
  v_exp_f32 v34, v34
  v_exp_f32 v35, v35
  v_exp_f32 v36, v36
  v_mfma_f32_32x32x16_bf16 v[48:63], v[16:19], v[12:15], 0.15915494
  s_waitcnt lgkmcnt(1)
  ds_read_b128 v[16:19], v240 offset:35360
  v_exp_f32 v37, v37
  v_exp_f32 v38, v38
  v_exp_f32 v39, v39
  v_exp_f32 v40, v40
  v_exp_f32 v41, v41
  v_smfmac_f32_32x32x32_bf16 v[64:79], v[20:23], v[32:39], v231
  s_waitcnt lgkmcnt(1)
  v_exp_f32 v42, v42
  v_exp_f32 v43, v43
  v_exp_f32 v44, v44
  v_exp_f32 v45, v45
  v_exp_f32 v46, v46
  v_exp_f32 v47, v47
  v_exp_f32 v48, v48
  v_exp_f32 v49, v49
  v_smfmac_f32_32x32x32_bf16 v[64:79], v[24:27], v[40:47], v231
  s_waitcnt lgkmcnt(0)
  v_exp_f32 v50, v50
  v_exp_f32 v51, v51
  v_exp_f32 v52, v52
  v_mfma_f32_32x32x16_bf16 v[32:47], v[16:19], v[8:11], 0.15915494
  s_cmp_lg_u32 s56, 0
  s_cbranch_scc1 L_noz2c
  s_and_b32 s75, s2, 1
  s_lshl_b32 s75, s75, 7
  s_mov_b64 exec, 1
  buffer_atomic_add v252, off, s[52:55], s75 offset:4
  s_mov_b64 exec, -1
L_noz2c:
  s_add_u32 s71, s57, 1
  s_and_b32 s71, s71, 3
  s_and_b32 s75, s57, 4
  s_or_b32 s71, s71, s75
  s_lshl_b32 s71, s71, 15
  s_add_u32 s71, s71, s70
  s_add_u32 m0, s72, 0
  s_nop 0
  buffer_load_dwordx4 v246, s[36:39], s71 offen offset:0 sc1 lds
  v_exp_f32 v53, v53
  v_exp_f32 v54, v54
  v_exp_f32 v55, v55
  v_exp_f32 v56, v56
  v_exp_f32 v57, v57
  v_smfmac_f32_32x32x32_bf16 v[80:95], v[20:23], v[48:55], v231
  ds_read_b128 v[20:23], v241 offset:35360
  v_exp_f32 v58, v58
  v_exp_f32 v59, v59
  v_exp_f32 v60, v60
  v_exp_f32 v61, v61
  v_exp_f32 v62, v62
  v_exp_f32 v63, v63
  v_exp_f32 v32, v32
  v_exp_f32 v33, v33
  v_smfmac_f32_32x32x32_bf16 v[80:95], v[24:27], v[56:63], v231
  ds_read_b128 v[24:27], v242 offset:35360
  v_exp_f32 v34, v34
  v_exp_f32 v35, v35
  v_exp_f32 v36, v36
  v_mfma_f32_32x32x16_bf16 v[48:63], v[16:19], v[12:15], 0.15915494
  s_waitcnt lgkmcnt(1)
  ds_read_b128 v[16:19], v240 offset:37440
  v_exp_f32 v37, v37
  v_exp_f32 v38, v38
  v_exp_f32 v39, v39
  v_exp_f32 v40, v40
  v_exp_f32 v41, v41
  v_smfmac_f32_32x32x32_bf16 v[64:79], v[20:23], v[32:39], v231
  s_waitcnt lgkmcnt(1)
  v_exp_f32 v42, v42
  v_exp_f32 v43, v43
  v_exp_f32 v44, v44
  v_exp_f32 v45, v45
  v_exp_f32 v46, v46
  v_exp_f32 v47, v47
  v_exp_f32 v48, v48
  v_exp_f32 v49, v49
  v_smfmac_f32_32x32x32_bf16 v[64:79], v[24:27], v[40:47], v231
  s_waitcnt lgkmcnt(0)
  v_exp_f32 v50, v50
  v_exp_f32 v51, v51
  v_exp_f32 v52, v52
  v_mfma_f32_32x32x16_bf16 v[32:47], v[16:19], v[8:11], 0.15915494
  buffer_load_dwordx4 v246, s[36:39], s71 offen offset:1024 sc1 lds
  v_exp_f32 v53, v53
  v_exp_f32 v54, v54
  v_exp_f32 v55, v55
  v_exp_f32 v56, v56
  v_exp_f32 v57, v57
  v_smfmac_f32_32x32x32_bf16 v[80:95], v[20:23], v[48:55], v231
  ds_read_b128 v[20:23], v241 offset:37440
  v_exp_f32 v58, v58
  v_exp_f32 v59, v59
  v_exp_f32 v60, v60
  v_exp_f32 v61, v61
  v_exp_f32 v62, v62
  v_exp_f32 v63, v63
  v_exp_f32 v32, v32
  v_exp_f32 v33, v33
  v_smfmac_f32_32x32x32_bf16 v[80:95], v[24:27], v[56:63], v231
  ds_read_b128 v[24:27], v242 offset:37440
  v_exp_f32 v34, v34
  v_exp_f32 v35, v35
  v_exp_f32 v36, v36
  v_mfma_f32_32x32x16_bf16 v[48:63], v[16:19], v[12:15], 0.15915494
  s_waitcnt lgkmcnt(1)
  ds_read_b128 v[16:19], v240 offset:39520
  v_exp_f32 v37, v37
  v_exp_f32 v38, v38
  v_exp_f32 v39, v39
  v_exp_f32 v40, v40
  v_exp_f32 v41, v41
  v_smfmac_f32_32x32x32_bf16 v[64:79], v[20:23], v[32:39], v231
  s_waitcnt lgkmcnt(1)
  v_exp_f32 v42, v42
  v_exp_f32 v43, v43
  v_exp_f32 v44, v44
  v_exp_f32 v45, v45
  v_exp_f32 v46, v46
  v_exp_f32 v47, v47
  v_exp_f32 v48, v48
  v_exp_f32 v49, v49
  v_smfmac_f32_32x32x32_bf16 v[64:79], v[24:27], v[40:47], v231
  s_waitcnt lgkmcnt(0)
  v_exp_f32 v50, v50
  v_exp_f32 v51, v51
  v_exp_f32 v52, v52
  v_mfma_f32_32x32x16_bf16 v[32:47], v[16:19], v[8:11], 0.15915494
  s_add_u32 m0, s72, 32
  s_nop 0
  buffer_load_dwordx4 v246, s[36:39], s71 offen offset:2048 sc1 lds
  v_exp_f32 v53, v53
  v_exp_f32 v54, v54
  v_exp_f32 v55, v55
  v_exp_f32 v56, v56
  v_exp_f32 v57, v57
  v_smfmac_f32_32x32x32_bf16 v[80:95], v[20:23], v[48:55], v231
  ds_read_b128 v[20:23], v241 offset:39520
  v_exp_f32 v58, v58
  v_exp_f32 v59, v59
  v_exp_f32 v60, v60
  v_exp_f32 v61, v61
  v_exp_f32 v62, v62
  v_exp_f32 v63, v63
  v_exp_f32 v32, v32
  v_exp_f32 v33, v33
  v_smfmac_f32_32x32x32_bf16 v[80:95], v[24:27], v[56:63], v231
  ds_read_b128 v[24:27], v242 offset:39520
  v_exp_f32 v34, v34
  v_exp_f32 v35, v35
  v_exp_f32 v36, v36
  v_mfma_f32_32x32x16_bf16 v[48:63], v[16:19], v[12:15], 0.15915494
  s_waitcnt lgkmcnt(1)
  ds_read_b128 v[16:19], v240 offset:41600
  v_exp_f32 v37, v37
  v_exp_f32 v38, v38
  v_exp_f32 v39, v39
  v_exp_f32 v40, v40
  v_exp_f32 v41, v41
  v_smfmac_f32_32x32x32_bf16 v[64:79], v[20:23], v[32:39], v231
  s_waitcnt lgkmcnt(1)
  v_exp_f32 v42, v42
  v_exp_f32 v43, v43
  v_exp_f32 v44, v44
  v_exp_f32 v45, v45
  v_exp_f32 v46, v46
  v_exp_f32 v47, v47
  v_exp_f32 v48, v48
  v_exp_f32 v49, v49
  v_smfmac_f32_32x32x32_bf16 v[64:79], v[24:27], v[40:47], v231
  s_waitcnt lgkmcnt(0)
  v_exp_f32 v50, v50
  v_exp_f32 v51, v51
  v_exp_f32 v52, v52
  v_mfma_f32_32x32x16_bf16 v[32:47], v[16:19], v[8:11], 0.15915494
  buffer_load_dwordx4 v246, s[36:39], s71 offen offset:3072 sc1 lds
  v_exp_f32 v53, v53
  v_exp_f32 v54, v54
  v_exp_f32 v55, v55
  v_exp_f32 v56, v56
  v_exp_f32 v57, v57
  v_smfmac_f32_32x32x32_bf16 v[80:95], v[20:23], v[48:55], v231
  ds_read_b128 v[20:23], v241 offset:41600
  v_exp_f32 v58, v58
  v_exp_f32 v59, v59
  v_exp_f32 v60, v60
  v_exp_f32 v61, v61
  v_exp_f32 v62, v62
  v_exp_f32 v63, v63
  v_exp_f32 v32, v32
  v_exp_f32 v33, v33
  v_smfmac_f32_32x32x32_bf16 v[80:95], v[24:27], v[56:63], v231
  ds_read_b128 v[24:27], v242 offset:41600
  v_exp_f32 v34, v34
  v_exp_f32 v35, v35
  v_exp_f32 v36, v36
  v_mfma_f32_32x32x16_bf16 v[48:63], v[16:19], v[12:15], 0.15915494
  s_waitcnt lgkmcnt(1)
  s_setprio 2
  ds_read_b128 v[16:19], v240 offset:43680
  v_exp_f32 v37, v37
  v_exp_f32 v38, v38
  v_exp_f32 v39, v39
  v_exp_f32 v40, v40
  v_exp_f32 v41, v41
  v_smfmac_f32_32x32x32_bf16 v[64:79], v[20:23], v[32:39], v231
  s_waitcnt lgkmcnt(1)
  v_exp_f32 v42, v42
  v_exp_f32 v43, v43
  v_exp_f32 v44, v44
  v_exp_f32 v45, v45
  v_exp_f32 v46, v46
  v_exp_f32 v47, v47
  v_exp_f32 v48, v48
  v_exp_f32 v49, v49
  v_smfmac_f32_32x32x32_bf16 v[64:79], v[24:27], v[40:47], v231
  s_waitcnt lgkmcnt(0)
  v_exp_f32 v50, v50
  v_exp_f32 v51, v51
  v_exp_f32 v52, v52
  v_mfma_f32_32x32x16_bf16 v[32:47], v[16:19], v[8:11], 0.15915494
  s_add_u32 m0, s74, 106496
  s_add_u32 s75, s73, 327680
  buffer_load_dwordx4 v247, s[44:47], s75 offen lds
  v_exp_f32 v53, v53
  v_exp_f32 v54, v54
  v_exp_f32 v55, v55
  v_exp_f32 v56, v56
  v_exp_f32 v57, v57
  v_smfmac_f32_32x32x32_bf16 v[80:95], v[20:23], v[48:55], v231
  ds_read_b128 v[20:23], v241 offset:43680
  v_exp_f32 v58, v58
  v_exp_f32 v59, v59
  v_exp_f32 v60, v60
  v_exp_f32 v61, v61
  v_exp_f32 v62, v62
  v_exp_f32 v63, v63
  v_exp_f32 v32, v32
  v_exp_f32 v33, v33
  v_smfmac_f32_32x32x32_bf16 v[80:95], v[24:27], v[56:63], v231
  ds_read_b128 v[24:27], v242 offset:43680
  v_exp_f32 v34, v34
  v_exp_f32 v35, v35
  v_exp_f32 v36, v36
  v_mfma_f32_32x32x16_bf16 v[48:63], v[16:19], v[12:15], 0.15915494
  s_waitcnt lgkmcnt(1)
  ds_read_b128 v[16:19], v240 offset:45760
  v_exp_f32 v37, v37
  v_exp_f32 v38, v38
  v_exp_f32 v39, v39
  v_exp_f32 v40, v40
  v_exp_f32 v41, v41
  v_smfmac_f32_32x32x32_bf16 v[64:79], v[20:23], v[32:39], v231
  s_waitcnt lgkmcnt(1)
  v_exp_f32 v42, v42
  v_exp_f32 v43, v43
  v_exp_f32 v44, v44
  v_exp_f32 v45, v45
  v_exp_f32 v46, v46
  v_exp_f32 v47, v47
  v_exp_f32 v48, v48
  v_exp_f32 v49, v49
  v_smfmac_f32_32x32x32_bf16 v[64:79], v[24:27], v[40:47], v231
  s_waitcnt lgkmcnt(0)
  v_exp_f32 v50, v50
  v_exp_f32 v51, v51
  v_exp_f32 v52, v52
  v_mfma_f32_32x32x16_bf16 v[32:47], v[16:19], v[8:11], 0.15915494
  s_setprio 1
  s_add_u32 m0, s74, 114688
  s_add_u32 s75, s73, 393216
  buffer_load_dwordx4 v247, s[44:47], s75 offen lds
  v_exp_f32 v53, v53
  v_exp_f32 v54, v54
  v_exp_f32 v55, v55
  v_exp_f32 v56, v56
  v_exp_f32 v57, v57
  v_smfmac_f32_32x32x32_bf16 v[80:95], v[20:23], v[48:55], v231
  ds_read_b128 v[20:23], v241 offset:45760
  v_exp_f32 v58, v58
  v_exp_f32 v59, v59
  v_exp_f32 v60, v60
  v_exp_f32 v61, v61
  v_exp_f32 v62, v62
  v_exp_f32 v63, v63
  v_exp_f32 v32, v32
  v_exp_f32 v33, v33
  v_smfmac_f32_32x32x32_bf16 v[80:95], v[24:27], v[56:63], v231
  ds_read_b128 v[24:27], v242 offset:45760
  v_exp_f32 v34, v34
  v_exp_f32 v35, v35
  v_exp_f32 v36, v36
  v_mfma_f32_32x32x16_bf16 v[48:63], v[16:19], v[12:15], 0.15915494
  s_waitcnt lgkmcnt(1)
  ds_read_b128 v[16:19], v240 offset:47840
  v_exp_f32 v37, v37
  v_exp_f32 v38, v38
  v_exp_f32 v39, v39
  v_exp_f32 v40, v40
  v_exp_f32 v41, v41
  v_smfmac_f32_32x32x32_bf16 v[64:79], v[20:23], v[32:39], v231
  s_waitcnt lgkmcnt(1)
  v_exp_f32 v42, v42
  v_exp_f32 v43, v43
  v_exp_f32 v44, v44
  v_exp_f32 v45, v45
  v_exp_f32 v46, v46
  v_exp_f32 v47, v47
  v_exp_f32 v48, v48
  v_exp_f32 v49, v49
  v_smfmac_f32_32x32x32_bf16 v[64:79], v[24:27], v[40:47], v231
  s_waitcnt lgkmcnt(0)
  v_exp_f32 v50, v50
  v_exp_f32 v51, v51
  v_exp_f32 v52, v52
  v_mfma_f32_32x32x16_bf16 v[32:47], v[16:19], v[8:11], 0.15915494
  s_setprio 0
  v_exp_f32 v53, v53
  v_exp_f32 v54, v54
  v_exp_f32 v55, v55
  v_exp_f32 v56, v56
  v_exp_f32 v57, v57
  v_smfmac_f32_32x32x32_bf16 v[80:95], v[20:23], v[48:55], v231
  ds_read_b128 v[20:23], v241 offset:47840
  v_exp_f32 v58, v58
  v_exp_f32 v59, v59
  v_exp_f32 v60, v60
  v_exp_f32 v61, v61
  v_exp_f32 v62, v62
  v_exp_f32 v63, v63
  v_exp_f32 v32, v32
  v_exp_f32 v33, v33
  v_smfmac_f32_32x32x32_bf16 v[80:95], v[24:27], v[56:63], v231
  ds_read_b128 v[24:27], v242 offset:47840
  v_exp_f32 v34, v34
  v_exp_f32 v35, v35
  v_exp_f32 v36, v36
  v_mfma_f32_32x32x16_bf16 v[48:63], v[16:19], v[12:15], 0.15915494
  s_waitcnt lgkmcnt(1)
  v_exp_f32 v37, v37
  v_exp_f32 v38, v38
  v_exp_f32 v39, v39
  v_exp_f32 v40, v40
  v_exp_f32 v41, v41
  v_smfmac_f32_32x32x32_bf16 v[64:79], v[20:23], v[32:39], v231
  s_waitcnt lgkmcnt(0)
  s_setprio 3
  s_waitcnt vmcnt(6)
  s_barrier
  ds_read_b128 v[16:19], v243 offset:0
  v_exp_f32 v42, v42
  v_exp_f32 v43, v43
  v_exp_f32 v44, v44
  v_exp_f32 v45, v45
  v_exp_f32 v46, v46
  v_exp_f32 v47, v47
  v_exp_f32 v48, v48
  v_exp_f32 v49, v49
  v_smfmac_f32_32x32x32_bf16 v[64:79], v[24:27], v[40:47], v231
  s_waitcnt lgkmcnt(0)
  v_exp_f32 v50, v50
  v_exp_f32 v51, v51
  v_exp_f32 v52, v52
  v_mfma_f32_32x32x16_bf16 v[32:47], v[16:19], v[8:11], 0.15915494
  v_exp_f32 v53, v53
  v_exp_f32 v54, v54
  v_exp_f32 v55, v55
  v_exp_f32 v56, v56
  v_exp_f32 v57, v57
  v_smfmac_f32_32x32x32_bf16 v[80:95], v[20:23], v[48:55], v231
  ds_read_b128 v[20:23], v244 offset:0
  v_exp_f32 v58, v58
  v_exp_f32 v59, v59
  v_exp_f32 v60, v60
  v_exp_f32 v61, v61
  v_exp_f32 v62, v62
  v_exp_f32 v63, v63
  v_exp_f32 v32, v32
  v_exp_f32 v33, v33
  v_smfmac_f32_32x32x32_bf16 v[80:95], v[24:27], v[56:63], v231
  ds_read_b128 v[24:27], v245 offset:0
  v_exp_f32 v34, v34
  v_exp_f32 v35, v35
  v_exp_f32 v36, v36
  v_mfma_f32_32x32x16_bf16 v[48:63], v[16:19], v[12:15], 0.15915494
  s_waitcnt lgkmcnt(1)
  ds_read_b128 v[16:19], v243 offset:2080
  v_exp_f32 v37, v37
  v_exp_f32 v38, v38
  v_exp_f32 v39, v39
  v_exp_f32 v40, v40
  v_exp_f32 v41, v41
  v_smfmac_f32_32x32x32_bf16 v[64:79], v[20:23], v[32:39], v231
  s_waitcnt lgkmcnt(1)
  v_exp_f32 v42, v42
  v_exp_f32 v43, v43
  v_exp_f32 v44, v44
  v_exp_f32 v45, v45
  v_exp_f32 v46, v46
  v_exp_f32 v47, v47
  v_exp_f32 v48, v48
  v_exp_f32 v49, v49
  v_smfmac_f32_32x32x32_bf16 v[64:79], v[24:27], v[40:47], v231
  s_waitcnt lgkmcnt(0)
  v_exp_f32 v50, v50
  v_exp_f32 v51, v51
  v_exp_f32 v52, v52
  v_mfma_f32_32x32x16_bf16 v[32:47], v[16:19], v[8:11], 0.15915494
  s_add_u32 s71, s57, 2
  s_and_b32 s71, s71, 3
  s_and_b32 s75, s57, 4
  s_or_b32 s71, s71, s75
  s_lshl_b32 s71, s71, 15
  s_add_u32 s71, s71, s70
  s_add_u32 m0, s72, 33280
  s_nop 0
  buffer_load_dwordx4 v246, s[36:39], s71 offen offset:0 sc1 lds
  v_exp_f32 v53, v53
  v_exp_f32 v54, v54
  v_exp_f32 v55, v55
  v_exp_f32 v56, v56
  v_exp_f32 v57, v57
  v_smfmac_f32_32x32x32_bf16 v[80:95], v[20:23], v[48:55], v231
  ds_read_b128 v[20:23], v244 offset:2080
  v_exp_f32 v58, v58
  v_exp_f32 v59, v59
  v_exp_f32 v60, v60
  v_exp_f32 v61, v61
  v_exp_f32 v62, v62
  v_exp_f32 v63, v63
  v_exp_f32 v32, v32
  v_exp_f32 v33, v33
  v_smfmac_f32_32x32x32_bf16 v[80:95], v[24:27], v[56:63], v231
  ds_read_b128 v[24:27], v245 offset:2080
  v_exp_f32 v34, v34
  v_exp_f32 v35, v35
  v_exp_f32 v36, v36
  v_mfma_f32_32x32x16_bf16 v[48:63], v[16:19], v[12:15], 0.15915494
  s_waitcnt lgkmcnt(1)
  ds_read_b128 v[16:19], v243 offset:4160
  v_exp_f32 v37, v37
  v_exp_f32 v38, v38
  v_exp_f32 v39, v39
  v_exp_f32 v40, v40
  v_exp_f32 v41, v41
  v_smfmac_f32_32x32x32_bf16 v[64:79], v[20:23], v[32:39], v231
  s_waitcnt lgkmcnt(1)
  v_exp_f32 v42, v42
  v_exp_f32 v43, v43
  v_exp_f32 v44, v44
  v_exp_f32 v45, v45
  v_exp_f32 v46, v46
  v_exp_f32 v47, v47
  v_exp_f32 v48, v48
  v_exp_f32 v49, v49
  v_smfmac_f32_32x32x32_bf16 v[64:79], v[24:27], v[40:47], v231
  s_waitcnt lgkmcnt(0)
  v_exp_f32 v50, v50
  v_exp_f32 v51, v51
  v_exp_f32 v52, v52
  v_mfma_f32_32x32x16_bf16 v[32:47], v[16:19], v[8:11], 0.15915494
  buffer_load_dwordx4 v246, s[36:39], s71 offen offset:1024 sc1 lds
  v_exp_f32 v53, v53
  v_exp_f32 v54, v54
  v_exp_f32 v55, v55
  v_exp_f32 v56, v56
  v_exp_f32 v57, v57
  v_smfmac_f32_32x32x32_bf16 v[80:95], v[20:23], v[48:55], v231
  ds_read_b128 v[20:23], v244 offset:4160
  v_exp_f32 v58, v58
  v_exp_f32 v59, v59
  v_exp_f32 v60, v60
  v_exp_f32 v61, v61
  v_exp_f32 v62, v62
  v_exp_f32 v63, v63
  v_exp_f32 v32, v32
  v_exp_f32 v33, v33
  v_smfmac_f32_32x32x32_bf16 v[80:95], v[24:27], v[56:63], v231
  ds_read_b128 v[24:27], v245 offset:4160
  v_exp_f32 v34, v34
  v_exp_f32 v35, v35
  v_exp_f32 v36, v36
  v_mfma_f32_32x32x16_bf16 v[48:63], v[16:19], v[12:15], 0.15915494
  s_waitcnt lgkmcnt(1)
  ds_read_b128 v[16:19], v243 offset:6240
  v_exp_f32 v37, v37
  v_exp_f32 v38, v38
  v_exp_f32 v39, v39
  v_exp_f32 v40, v40
  v_exp_f32 v41, v41
  v_smfmac_f32_32x32x32_bf16 v[64:79], v[20:23], v[32:39], v231
  s_waitcnt lgkmcnt(1)
  v_exp_f32 v42, v42
  v_exp_f32 v43, v43
  v_exp_f32 v44, v44
  v_exp_f32 v45, v45
  v_exp_f32 v46, v46
  v_exp_f32 v47, v47
  v_exp_f32 v48, v48
  v_exp_f32 v49, v49
  v_smfmac_f32_32x32x32_bf16 v[64:79], v[24:27], v[40:47], v231
  s_waitcnt lgkmcnt(0)
  v_exp_f32 v50, v50
  v_exp_f32 v51, v51
  v_exp_f32 v52, v52
  v_mfma_f32_32x32x16_bf16 v[32:47], v[16:19], v[8:11], 0.15915494
  s_add_u32 m0, s72, 33312
  s_nop 0
  buffer_load_dwordx4 v246, s[36:39], s71 offen offset:2048 sc1 lds
  v_exp_f32 v53, v53
  v_exp_f32 v54, v54
  v_exp_f32 v55, v55
  v_exp_f32 v56, v56
  v_exp_f32 v57, v57
  v_smfmac_f32_32x32x32_bf16 v[80:95], v[20:23], v[48:55], v231
  ds_read_b128 v[20:23], v244 offset:6240
  v_exp_f32 v58, v58
  v_exp_f32 v59, v59
  v_exp_f32 v60, v60
  v_exp_f32 v61, v61
  v_exp_f32 v62, v62
  v_exp_f32 v63, v63
  v_exp_f32 v32, v32
  v_exp_f32 v33, v33
  v_smfmac_f32_32x32x32_bf16 v[80:95], v[24:27], v[56:63], v231
  ds_read_b128 v[24:27], v245 offset:6240
  v_exp_f32 v34, v34
  v_exp_f32 v35, v35
  v_exp_f32 v36, v36
  v_mfma_f32_32x32x16_bf16 v[48:63], v[16:19], v[12:15], 0.15915494
  s_waitcnt lgkmcnt(1)
  ds_read_b128 v[16:19], v243 offset:8320
  v_exp_f32 v37, v37
  v_exp_f32 v38, v38
  v_exp_f32 v39, v39
  v_exp_f32 v40, v40
  v_exp_f32 v41, v41
  v_smfmac_f32_32x32x32_bf16 v[64:79], v[20:23], v[32:39], v231
  s_waitcnt lgkmcnt(1)
  v_exp_f32 v42, v42
  v_exp_f32 v43, v43
  v_exp_f32 v44, v44
  v_exp_f32 v45, v45
  v_exp_f32 v46, v46
  v_exp_f32 v47, v47
  v_exp_f32 v48, v48
  v_exp_f32 v49, v49
  v_smfmac_f32_32x32x32_bf16 v[64:79], v[24:27], v[40:47], v231
  s_waitcnt lgkmcnt(0)
  v_exp_f32 v50, v50
  v_exp_f32 v51, v51
  v_exp_f32 v52, v52
  v_mfma_f32_32x32x16_bf16 v[32:47], v[16:19], v[8:11], 0.15915494
  buffer_load_dwordx4 v246, s[36:39], s71 offen offset:3072 sc1 lds
  v_exp_f32 v53, v53
  v_exp_f32 v54, v54
  v_exp_f32 v55, v55
  v_exp_f32 v56, v56
  v_exp_f32 v57, v57
  v_smfmac_f32_32x32x32_bf16 v[80:95], v[20:23], v[48:55], v231
  ds_read_b128 v[20:23], v244 offset:8320
  v_exp_f32 v58, v58
  v_exp_f32 v59, v59
  v_exp_f32 v60, v60
  v_exp_f32 v61, v61
  v_exp_f32 v62, v62
  v_exp_f32 v63, v63
  v_exp_f32 v32, v32
  v_exp_f32 v33, v33
  v_smfmac_f32_32x32x32_bf16 v[80:95], v[24:27], v[56:63], v231
  ds_read_b128 v[24:27], v245 offset:8320
  v_exp_f32 v34, v34
  v_exp_f32 v35, v35
  v_exp_f32 v36, v36
  v_mfma_f32_32x32x16_bf16 v[48:63], v[16:19], v[12:15], 0.15915494
  s_waitcnt lgkmcnt(1)
  s_setprio 2
  ds_read_b128 v[16:19], v243 offset:10400
  v_exp_f32 v37, v37
  v_exp_f32 v38, v38
  v_exp_f32 v39, v39
  v_exp_f32 v40, v40
  v_exp_f32 v41, v41
  v_smfmac_f32_32x32x32_bf16 v[64:79], v[20:23], v[32:39], v231
  s_waitcnt lgkmcnt(1)
  v_exp_f32 v42, v42
  v_exp_f32 v43, v43
  v_exp_f32 v44, v44
  v_exp_f32 v45, v45
  v_exp_f32 v46, v46
  v_exp_f32 v47, v47
  v_exp_f32 v48, v48
  v_exp_f32 v49, v49
  v_smfmac_f32_32x32x32_bf16 v[64:79], v[24:27], v[40:47], v231
  s_waitcnt lgkmcnt(0)
  v_exp_f32 v50, v50
  v_exp_f32 v51, v51
  v_exp_f32 v52, v52
  v_mfma_f32_32x32x16_bf16 v[32:47], v[16:19], v[8:11], 0.15915494
  v_exp_f32 v53, v53
  v_exp_f32 v54, v54
  v_exp_f32 v55, v55
  v_exp_f32 v56, v56
  v_exp_f32 v57, v57
  v_smfmac_f32_32x32x32_bf16 v[80:95], v[20:23], v[48:55], v231
  ds_read_b128 v[20:23], v244 offset:10400
  v_exp_f32 v58, v58
  v_exp_f32 v59, v59
  v_exp_f32 v60, v60
  v_exp_f32 v61, v61
  v_exp_f32 v62, v62
  v_exp_f32 v63, v63
  v_exp_f32 v32, v32
  v_exp_f32 v33, v33
  v_smfmac_f32_32x32x32_bf16 v[80:95], v[24:27], v[56:63], v231
  ds_read_b128 v[24:27], v245 offset:10400
  v_exp_f32 v34, v34
  v_exp_f32 v35, v35
  v_exp_f32 v36, v36
  v_mfma_f32_32x32x16_bf16 v[48:63], v[16:19], v[12:15], 0.15915494
  s_waitcnt lgkmcnt(1)
  ds_read_b128 v[16:19], v243 offset:12480
  v_exp_f32 v37, v37
  v_exp_f32 v38, v38
  v_exp_f32 v39, v39
  v_exp_f32 v40, v40
  v_exp_f32 v41, v41
  v_smfmac_f32_32x32x32_bf16 v[64:79], v[20:23], v[32:39], v231
  s_waitcnt lgkmcnt(1)
  v_exp_f32 v42, v42
  v_exp_f32 v43, v43
  v_exp_f32 v44, v44
  v_exp_f32 v45, v45
  v_exp_f32 v46, v46
  v_exp_f32 v47, v47
  v_exp_f32 v48, v48
  v_exp_f32 v49, v49
  v_smfmac_f32_32x32x32_bf16 v[64:79], v[24:27], v[40:47], v231
  s_waitcnt lgkmcnt(0)
  v_exp_f32 v50, v50
  v_exp_f32 v51, v51
  v_exp_f32 v52, v52
  v_mfma_f32_32x32x16_bf16 v[32:47], v[16:19], v[8:11], 0.15915494
  s_setprio 1
  v_exp_f32 v53, v53
  v_exp_f32 v54, v54
  v_exp_f32 v55, v55
  v_exp_f32 v56, v56
  v_exp_f32 v57, v57
  v_smfmac_f32_32x32x32_bf16 v[80:95], v[20:23], v[48:55], v231
  ds_read_b128 v[20:23], v244 offset:12480
  v_exp_f32 v58, v58
  v_exp_f32 v59, v59
  v_exp_f32 v60, v60
  v_exp_f32 v61, v61
  v_exp_f32 v62, v62
  v_exp_f32 v63, v63
  v_exp_f32 v32, v32
  v_exp_f32 v33, v33
  v_smfmac_f32_32x32x32_bf16 v[80:95], v[24:27], v[56:63], v231
  ds_read_b128 v[24:27], v245 offset:12480
  v_exp_f32 v34, v34
  v_exp_f32 v35, v35
  v_exp_f32 v36, v36
  v_mfma_f32_32x32x16_bf16 v[48:63], v[16:19], v[12:15], 0.15915494
  s_waitcnt lgkmcnt(1)
  ds_read_b128 v[16:19], v243 offset:14560
  v_exp_f32 v37, v37
  v_exp_f32 v38, v38
  v_exp_f32 v39, v39
  v_exp_f32 v40, v40
  v_exp_f32 v41, v41
  v_smfmac_f32_32x32x32_bf16 v[64:79], v[20:23], v[32:39], v231
  s_waitcnt lgkmcnt(1)
  v_exp_f32 v42, v42
  v_exp_f32 v43, v43
  v_exp_f32 v44, v44
  v_exp_f32 v45, v45
  v_exp_f32 v46, v46
  v_exp_f32 v47, v47
  v_exp_f32 v48, v48
  v_exp_f32 v49, v49
  v_smfmac_f32_32x32x32_bf16 v[64:79], v[24:27], v[40:47], v231
  s_waitcnt lgkmcnt(0)
  v_exp_f32 v50, v50
  v_exp_f32 v51, v51
  v_exp_f32 v52, v52
  v_mfma_f32_32x32x16_bf16 v[32:47], v[16:19], v[8:11], 0.15915494
  s_setprio 0
  v_exp_f32 v53, v53
  v_exp_f32 v54, v54
  v_exp_f32 v55, v55
  v_exp_f32 v56, v56
  v_exp_f32 v57, v57
  v_smfmac_f32_32x32x32_bf16 v[80:95], v[20:23], v[48:55], v231
  ds_read_b128 v[20:23], v244 offset:14560
  v_exp_f32 v58, v58
  v_exp_f32 v59, v59
  v_exp_f32 v60, v60
  v_exp_f32 v61, v61
  v_exp_f32 v62, v62
  v_exp_f32 v63, v63
  v_exp_f32 v32, v32
  v_exp_f32 v33, v33
  v_smfmac_f32_32x32x32_bf16 v[80:95], v[24:27], v[56:63], v231
  ds_read_b128 v[24:27], v245 offset:14560
  v_exp_f32 v34, v34
  v_exp_f32 v35, v35
  v_exp_f32 v36, v36
  v_mfma_f32_32x32x16_bf16 v[48:63], v[16:19], v[12:15], 0.15915494
  s_waitcnt lgkmcnt(1)
  v_exp_f32 v37, v37
  v_exp_f32 v38, v38
  v_exp_f32 v39, v39
  v_exp_f32 v40, v40
  v_exp_f32 v41, v41
  v_smfmac_f32_32x32x32_bf16 v[64:79], v[20:23], v[32:39], v231
  s_waitcnt lgkmcnt(0)
  s_setprio 3
  s_waitcnt vmcnt(4)
  s_barrier
  ds_read_b128 v[16:19], v240 offset:0
  v_exp_f32 v42, v42
  v_exp_f32 v43, v43
  v_exp_f32 v44, v44
  v_exp_f32 v45, v45
  v_exp_f32 v46, v46
  v_exp_f32 v47, v47
  v_exp_f32 v48, v48
  v_exp_f32 v49, v49
  v_smfmac_f32_32x32x32_bf16 v[64:79], v[24:27], v[40:47], v231
  s_waitcnt lgkmcnt(0)
  v_exp_f32 v50, v50
  v_exp_f32 v51, v51
  v_exp_f32 v52, v52
  v_mfma_f32_32x32x16_bf16 v[32:47], v[16:19], v[8:11], 0.15915494
  v_exp_f32 v53, v53
  v_exp_f32 v54, v54
  v_exp_f32 v55, v55
  v_exp_f32 v56, v56
  v_exp_f32 v57, v57
  v_smfmac_f32_32x32x32_bf16 v[80:95], v[20:23], v[48:55], v231
  ds_read_b128 v[20:23], v241 offset:0
  v_exp_f32 v58, v58
  v_exp_f32 v59, v59
  v_exp_f32 v60, v60
  v_exp_f32 v61, v61
  v_exp_f32 v62, v62
  v_exp_f32 v63, v63
  v_exp_f32 v32, v32
  v_exp_f32 v33, v33
  v_smfmac_f32_32x32x32_bf16 v[80:95], v[24:27], v[56:63], v231
  ds_read_b128 v[24:27], v242 offset:0
  v_exp_f32 v34, v34
  v_exp_f32 v35, v35
  v_exp_f32 v36, v36
  v_mfma_f32_32x32x16_bf16 v[48:63], v[16:19], v[12:15], 0.15915494
  s_waitcnt lgkmcnt(1)
  ds_read_b128 v[16:19], v240 offset:2080
  v_exp_f32 v37, v37
  v_exp_f32 v38, v38
  v_exp_f32 v39, v39
  v_exp_f32 v40, v40
  v_exp_f32 v41, v41
  v_smfmac_f32_32x32x32_bf16 v[64:79], v[20:23], v[32:39], v231
  s_waitcnt lgkmcnt(1)
  v_exp_f32 v42, v42
  v_exp_f32 v43, v43
  v_exp_f32 v44, v44
  v_exp_f32 v45, v45
  v_exp_f32 v46, v46
  v_exp_f32 v47, v47
  v_exp_f32 v48, v48
  v_exp_f32 v49, v49
  v_smfmac_f32_32x32x32_bf16 v[64:79], v[24:27], v[40:47], v231
  s_waitcnt lgkmcnt(0)
  v_exp_f32 v50, v50
  v_exp_f32 v51, v51
  v_exp_f32 v52, v52
  v_mfma_f32_32x32x16_bf16 v[32:47], v[16:19], v[8:11], 0.15915494
  s_cmp_eq_u32 s56, 0
  s_cselect_b32 exec_lo, 3, 0
  s_mov_b32 exec_hi, 0
  buffer_load_dword v255, v254, s[52:55], 0 offen offset:4 sc1
  s_mov_b64 exec, -1
  s_add_u32 s71, s57, 3
  s_and_b32 s71, s71, 3
  s_and_b32 s75, s57, 4
  s_or_b32 s71, s71, s75
  s_lshl_b32 s71, s71, 15
  s_add_u32 s71, s71, s70
  s_add_u32 m0, s72, 130560
  s_nop 0
  buffer_load_dwordx4 v246, s[36:39], s71 offen offset:0 sc1 lds
  v_exp_f32 v53, v53
  v_exp_f32 v54, v54
  v_exp_f32 v55, v55
  v_exp_f32 v56, v56
  v_exp_f32 v57, v57
  v_smfmac_f32_32x32x32_bf16 v[80:95], v[20:23], v[48:55], v231
  ds_read_b128 v[20:23], v241 offset:2080
  v_exp_f32 v58, v58
  v_exp_f32 v59, v59
  v_exp_f32 v60, v60
  v_exp_f32 v61, v61
  v_exp_f32 v62, v62
  v_exp_f32 v63, v63
  v_exp_f32 v32, v32
  v_exp_f32 v33, v33
  v_smfmac_f32_32x32x32_bf16 v[80:95], v[24:27], v[56:63], v231
  ds_read_b128 v[24:27], v242 offset:2080
  v_exp_f32 v34, v34
  v_exp_f32 v35, v35
  v_exp_f32 v36, v36
  v_mfma_f32_32x32x16_bf16 v[48:63], v[16:19], v[12:15], 0.15915494
  s_waitcnt lgkmcnt(1)
  ds_read_b128 v[16:19], v240 offset:4160
  v_exp_f32 v37, v37
  v_exp_f32 v38, v38
  v_exp_f32 v39, v39
  v_exp_f32 v40, v40
  v_exp_f32 v41, v41
  v_smfmac_f32_32x32x32_bf16 v[64:79], v[20:23], v[32:39], v231
  s_waitcnt lgkmcnt(1)
  v_exp_f32 v42, v42
  v_exp_f32 v43, v43
  v_exp_f32 v44, v44
  v_exp_f32 v45, v45
  v_exp_f32 v46, v46
  v_exp_f32 v47, v47
  v_exp_f32 v48, v48
  v_exp_f32 v49, v49
  v_smfmac_f32_32x32x32_bf16 v[64:79], v[24:27], v[40:47], v231
  s_waitcnt lgkmcnt(0)
  v_exp_f32 v50, v50
  v_exp_f32 v51, v51
  v_exp_f32 v52, v52
  v_mfma_f32_32x32x16_bf16 v[32:47], v[16:19], v[8:11], 0.15915494
  buffer_load_dwordx4 v246, s[36:39], s71 offen offset:1024 sc1 lds
  v_exp_f32 v53, v53
  v_exp_f32 v54, v54
  v_exp_f32 v55, v55
  v_exp_f32 v56, v56
  v_exp_f32 v57, v57
  v_smfmac_f32_32x32x32_bf16 v[80:95], v[20:23], v[48:55], v231
  ds_read_b128 v[20:23], v241 offset:4160
  v_exp_f32 v58, v58
  v_exp_f32 v59, v59
  v_exp_f32 v60, v60
  v_exp_f32 v61, v61
  v_exp_f32 v62, v62
  v_exp_f32 v63, v63
  v_exp_f32 v32, v32
  v_exp_f32 v33, v33
  v_smfmac_f32_32x32x32_bf16 v[80:95], v[24:27], v[56:63], v231
  ds_read_b128 v[24:27], v242 offset:4160
  v_exp_f32 v34, v34
  v_exp_f32 v35, v35
  v_exp_f32 v36, v36
  v_mfma_f32_32x32x16_bf16 v[48:63], v[16:19], v[12:15], 0.15915494
  s_waitcnt lgkmcnt(1)
  ds_read_b128 v[16:19], v240 offset:6240
  v_exp_f32 v37, v37
  v_exp_f32 v38, v38
  v_exp_f32 v39, v39
  v_exp_f32 v40, v40
  v_exp_f32 v41, v41
  v_smfmac_f32_32x32x32_bf16 v[64:79], v[20:23], v[32:39], v231
  s_waitcnt lgkmcnt(1)
  v_exp_f32 v42, v42
  v_exp_f32 v43, v43
  v_exp_f32 v44, v44
  v_exp_f32 v45, v45
  v_exp_f32 v46, v46
  v_exp_f32 v47, v47
  v_exp_f32 v48, v48
  v_exp_f32 v49, v49
  v_smfmac_f32_32x32x32_bf16 v[64:79], v[24:27], v[40:47], v231
  s_waitcnt lgkmcnt(0)
  v_exp_f32 v50, v50
  v_exp_f32 v51, v51
  v_exp_f32 v52, v52
  v_mfma_f32_32x32x16_bf16 v[32:47], v[16:19], v[8:11], 0.15915494
  s_add_u32 m0, s72, 130592
  s_nop 0
  buffer_load_dwordx4 v246, s[36:39], s71 offen offset:2048 sc1 lds
  v_exp_f32 v53, v53
  v_exp_f32 v54, v54
  v_exp_f32 v55, v55
  v_exp_f32 v56, v56
  v_exp_f32 v57, v57
  v_smfmac_f32_32x32x32_bf16 v[80:95], v[20:23], v[48:55], v231
  ds_read_b128 v[20:23], v241 offset:6240
  v_exp_f32 v58, v58
  v_exp_f32 v59, v59
  v_exp_f32 v60, v60
  v_exp_f32 v61, v61
  v_exp_f32 v62, v62
  v_exp_f32 v63, v63
  v_exp_f32 v32, v32
  v_exp_f32 v33, v33
  v_smfmac_f32_32x32x32_bf16 v[80:95], v[24:27], v[56:63], v231
  ds_read_b128 v[24:27], v242 offset:6240
  v_exp_f32 v34, v34
  v_exp_f32 v35, v35
  v_exp_f32 v36, v36
  v_mfma_f32_32x32x16_bf16 v[48:63], v[16:19], v[12:15], 0.15915494
  s_waitcnt lgkmcnt(1)
  ds_read_b128 v[16:19], v240 offset:8320
  v_exp_f32 v37, v37
  v_exp_f32 v38, v38
  v_exp_f32 v39, v39
  v_exp_f32 v40, v40
  v_exp_f32 v41, v41
  v_smfmac_f32_32x32x32_bf16 v[64:79], v[20:23], v[32:39], v231
  s_waitcnt lgkmcnt(1)
  v_exp_f32 v42, v42
  v_exp_f32 v43, v43
  v_exp_f32 v44, v44
  v_exp_f32 v45, v45
  v_exp_f32 v46, v46
  v_exp_f32 v47, v47
  v_exp_f32 v48, v48
  v_exp_f32 v49, v49
  v_smfmac_f32_32x32x32_bf16 v[64:79], v[24:27], v[40:47], v231
  s_waitcnt lgkmcnt(0)
  v_exp_f32 v50, v50
  v_exp_f32 v51, v51
  v_exp_f32 v52, v52
  v_mfma_f32_32x32x16_bf16 v[32:47], v[16:19], v[8:11], 0.15915494
  buffer_load_dwordx4 v246, s[36:39], s71 offen offset:3072 sc1 lds
  v_exp_f32 v53, v53
  v_exp_f32 v54, v54
  v_exp_f32 v55, v55
  v_exp_f32 v56, v56
  v_exp_f32 v57, v57
  v_smfmac_f32_32x32x32_bf16 v[80:95], v[20:23], v[48:55], v231
  ds_read_b128 v[20:23], v241 offset:8320
  v_exp_f32 v58, v58
  v_exp_f32 v59, v59
  v_exp_f32 v60, v60
  v_exp_f32 v61, v61
  v_exp_f32 v62, v62
  v_exp_f32 v63, v63
  v_exp_f32 v32, v32
  v_exp_f32 v33, v33
  v_smfmac_f32_32x32x32_bf16 v[80:95], v[24:27], v[56:63], v231
  ds_read_b128 v[24:27], v242 offset:8320
  v_exp_f32 v34, v34
  v_exp_f32 v35, v35
  v_exp_f32 v36, v36
  v_mfma_f32_32x32x16_bf16 v[48:63], v[16:19], v[12:15], 0.15915494
  s_waitcnt lgkmcnt(1)
  s_setprio 2
  ds_read_b128 v[16:19], v240 offset:10400
  v_exp_f32 v37, v37
  v_exp_f32 v38, v38
  v_exp_f32 v39, v39
  v_exp_f32 v40, v40
  v_exp_f32 v41, v41
  v_smfmac_f32_32x32x32_bf16 v[64:79], v[20:23], v[32:39], v231
  s_waitcnt lgkmcnt(1)
  v_exp_f32 v42, v42
  v_exp_f32 v43, v43
  v_exp_f32 v44, v44
  v_exp_f32 v45, v45
  v_exp_f32 v46, v46
  v_exp_f32 v47, v47
  v_exp_f32 v48, v48
  v_exp_f32 v49, v49
  v_smfmac_f32_32x32x32_bf16 v[64:79], v[24:27], v[40:47], v231
  s_waitcnt lgkmcnt(0)
  v_exp_f32 v50, v50
  v_exp_f32 v51, v51
  v_exp_f32 v52, v52
  v_mfma_f32_32x32x16_bf16 v[32:47], v[16:19], v[8:11], 0.15915494
  v_exp_f32 v53, v53
  v_exp_f32 v54, v54
  v_exp_f32 v55, v55
  v_exp_f32 v56, v56
  v_exp_f32 v57, v57
  v_smfmac_f32_32x32x32_bf16 v[80:95], v[20:23], v[48:55], v231
  ds_read_b128 v[20:23], v241 offset:10400
  v_exp_f32 v58, v58
  v_exp_f32 v59, v59
  v_exp_f32 v60, v60
  v_exp_f32 v61, v61
  v_exp_f32 v62, v62
  v_exp_f32 v63, v63
  v_exp_f32 v32, v32
  v_exp_f32 v33, v33
  v_smfmac_f32_32x32x32_bf16 v[80:95], v[24:27], v[56:63], v231
  ds_read_b128 v[24:27], v242 offset:10400
  v_exp_f32 v34, v34
  v_exp_f32 v35, v35
  v_exp_f32 v36, v36
  v_mfma_f32_32x32x16_bf16 v[48:63], v[16:19], v[12:15], 0.15915494
  s_waitcnt lgkmcnt(1)
  ds_read_b128 v[16:19], v240 offset:12480
  v_exp_f32 v37, v37
  v_exp_f32 v38, v38
  v_exp_f32 v39, v39
  v_exp_f32 v40, v40
  v_exp_f32 v41, v41
  v_smfmac_f32_32x32x32_bf16 v[64:79], v[20:23], v[32:39], v231
  s_waitcnt lgkmcnt(1)
  v_exp_f32 v42, v42
  v_exp_f32 v43, v43
  v_exp_f32 v44, v44
  v_exp_f32 v45, v45
  v_exp_f32 v46, v46
  v_exp_f32 v47, v47
  v_exp_f32 v48, v48
  v_exp_f32 v49, v49
  v_smfmac_f32_32x32x32_bf16 v[64:79], v[24:27], v[40:47], v231
  s_waitcnt lgkmcnt(0)
  v_exp_f32 v50, v50
  v_exp_f32 v51, v51
  v_exp_f32 v52, v52
  v_mfma_f32_32x32x16_bf16 v[32:47], v[16:19], v[8:11], 0.15915494
  s_setprio 1
  v_exp_f32 v53, v53
  v_exp_f32 v54, v54
  v_exp_f32 v55, v55
  v_exp_f32 v56, v56
  v_exp_f32 v57, v57
  v_smfmac_f32_32x32x32_bf16 v[80:95], v[20:23], v[48:55], v231
  ds_read_b128 v[20:23], v241 offset:12480
  v_exp_f32 v58, v58
  v_exp_f32 v59, v59
  v_exp_f32 v60, v60
  v_exp_f32 v61, v61
  v_exp_f32 v62, v62
  v_exp_f32 v63, v63
  v_exp_f32 v32, v32
  v_exp_f32 v33, v33
  v_smfmac_f32_32x32x32_bf16 v[80:95], v[24:27], v[56:63], v231
  ds_read_b128 v[24:27], v242 offset:12480
  v_exp_f32 v34, v34
  v_exp_f32 v35, v35
  v_exp_f32 v36, v36
  v_mfma_f32_32x32x16_bf16 v[48:63], v[16:19], v[12:15], 0.15915494
  s_waitcnt lgkmcnt(1)
  ds_read_b128 v[16:19], v240 offset:14560
  v_exp_f32 v37, v37
  v_exp_f32 v38, v38
  v_exp_f32 v39, v39
  v_exp_f32 v40, v40
  v_exp_f32 v41, v41
  v_smfmac_f32_32x32x32_bf16 v[64:79], v[20:23], v[32:39], v231
  s_waitcnt lgkmcnt(1)
  v_exp_f32 v42, v42
  v_exp_f32 v43, v43
  v_exp_f32 v44, v44
  v_exp_f32 v45, v45
  v_exp_f32 v46, v46
  v_exp_f32 v47, v47
  v_exp_f32 v48, v48
  v_exp_f32 v49, v49
  v_smfmac_f32_32x32x32_bf16 v[64:79], v[24:27], v[40:47], v231
  s_waitcnt lgkmcnt(0)
  v_exp_f32 v50, v50
  v_exp_f32 v51, v51
  v_exp_f32 v52, v52
  v_mfma_f32_32x32x16_bf16 v[32:47], v[16:19], v[8:11], 0.15915494
  s_setprio 0
  v_exp_f32 v53, v53
  v_exp_f32 v54, v54
  v_exp_f32 v55, v55
  v_exp_f32 v56, v56
  v_exp_f32 v57, v57
  v_smfmac_f32_32x32x32_bf16 v[80:95], v[20:23], v[48:55], v231
  ds_read_b128 v[20:23], v241 offset:14560
  v_exp_f32 v58, v58
  v_exp_f32 v59, v59
  v_exp_f32 v60, v60
  v_exp_f32 v61, v61
  v_exp_f32 v62, v62
  v_exp_f32 v63, v63
  v_exp_f32 v32, v32
  v_exp_f32 v33, v33
  v_smfmac_f32_32x32x32_bf16 v[80:95], v[24:27], v[56:63], v231
  ds_read_b128 v[24:27], v242 offset:14560
  v_exp_f32 v34, v34
  v_exp_f32 v35, v35
  v_exp_f32 v36, v36
  v_mfma_f32_32x32x16_bf16 v[48:63], v[16:19], v[12:15], 0.15915494
  s_waitcnt lgkmcnt(1)
  v_exp_f32 v37, v37
  v_exp_f32 v38, v38
  v_exp_f32 v39, v39
  v_exp_f32 v40, v40
  v_exp_f32 v41, v41
  v_smfmac_f32_32x32x32_bf16 v[64:79], v[20:23], v[32:39], v231
  s_waitcnt lgkmcnt(0)
  s_setprio 3
  s_movk_i32 s75, 128
  s_waitcnt vmcnt(4)
  v_cmp_gt_u32 vcc, s75, v255
  s_nop 0
  s_cbranch_vccnz L_spin_z2
L_ret_z2:
  s_barrier
  ds_read_b128 v[16:19], v240 offset:33280
  v_exp_f32 v42, v42
  v_exp_f32 v43, v43
  v_exp_f32 v44, v44
  v_exp_f32 v45, v45
  v_exp_f32 v46, v46
  v_exp_f32 v47, v47
  v_exp_f32 v48, v48
  v_exp_f32 v49, v49
  v_smfmac_f32_32x32x32_bf16 v[64:79], v[24:27], v[40:47], v231
  s_waitcnt lgkmcnt(0)
  v_exp_f32 v50, v50
  v_exp_f32 v51, v51
  v_exp_f32 v52, v52
  v_mfma_f32_32x32x16_bf16 v[32:47], v[16:19], v[8:11], 0.15915494
  v_exp_f32 v53, v53
  v_exp_f32 v54, v54
  v_exp_f32 v55, v55
  v_exp_f32 v56, v56
  v_exp_f32 v57, v57
  v_smfmac_f32_32x32x32_bf16 v[80:95], v[20:23], v[48:55], v231
  ds_read_b128 v[20:23], v241 offset:33280
  v_exp_f32 v58, v58
  v_exp_f32 v59, v59
  v_exp_f32 v60, v60
  v_exp_f32 v61, v61
  v_exp_f32 v62, v62
  v_exp_f32 v63, v63
  v_exp_f32 v32, v32
  v_exp_f32 v33, v33
  v_smfmac_f32_32x32x32_bf16 v[80:95], v[24:27], v[56:63], v231
  ds_read_b128 v[24:27], v242 offset:33280
  v_exp_f32 v34, v34
  v_exp_f32 v35, v35
  v_exp_f32 v36, v36
  v_mfma_f32_32x32x16_bf16 v[48:63], v[16:19], v[12:15], 0.15915494
  s_waitcnt lgkmcnt(1)
  ds_read_b128 v[16:19], v240 offset:35360
  v_exp_f32 v37, v37
  v_exp_f32 v38, v38
  v_exp_f32 v39, v39
  v_exp_f32 v40, v40
  v_exp_f32 v41, v41
  v_smfmac_f32_32x32x32_bf16 v[64:79], v[20:23], v[32:39], v231
  s_waitcnt lgkmcnt(1)
  v_exp_f32 v42, v42
  v_exp_f32 v43, v43
  v_exp_f32 v44, v44
  v_exp_f32 v45, v45
  v_exp_f32 v46, v46
  v_exp_f32 v47, v47
  v_exp_f32 v48, v48
  v_exp_f32 v49, v49
  v_smfmac_f32_32x32x32_bf16 v[64:79], v[24:27], v[40:47], v231
  s_waitcnt lgkmcnt(0)
  v_exp_f32 v50, v50
  v_exp_f32 v51, v51
  v_exp_f32 v52, v52
  v_mfma_f32_32x32x16_bf16 v[32:47], v[16:19], v[8:11], 0.15915494
  s_add_u32 m0, s74, 0
  s_add_u32 s75, s73, 0
  buffer_load_dwordx4 v247, s[40:43], s75 offen lds
  v_exp_f32 v53, v53
  v_exp_f32 v54, v54
  v_exp_f32 v55, v55
  v_exp_f32 v56, v56
  v_exp_f32 v57, v57
  v_smfmac_f32_32x32x32_bf16 v[80:95], v[20:23], v[48:55], v231
  ds_read_b128 v[20:23], v241 offset:35360
  v_exp_f32 v58, v58
  v_exp_f32 v59, v59
  v_exp_f32 v60, v60
  v_exp_f32 v61, v61
  v_exp_f32 v62, v62
  v_exp_f32 v63, v63
  v_exp_f32 v32, v32
  v_exp_f32 v33, v33
  v_smfmac_f32_32x32x32_bf16 v[80:95], v[24:27], v[56:63], v231
  ds_read_b128 v[24:27], v242 offset:35360
  v_exp_f32 v34, v34
  v_exp_f32 v35, v35
  v_exp_f32 v36, v36
  v_mfma_f32_32x32x16_bf16 v[48:63], v[16:19], v[12:15], 0.15915494
  s_waitcnt lgkmcnt(1)
  ds_read_b128 v[16:19], v240 offset:37440
  v_exp_f32 v37, v37
  v_exp_f32 v38, v38
  v_exp_f32 v39, v39
  v_exp_f32 v40, v40
  v_exp_f32 v41, v41
  v_smfmac_f32_32x32x32_bf16 v[64:79], v[20:23], v[32:39], v231
  s_waitcnt lgkmcnt(1)
  v_exp_f32 v42, v42
  v_exp_f32 v43, v43
  v_exp_f32 v44, v44
  v_exp_f32 v45, v45
  v_exp_f32 v46, v46
  v_exp_f32 v47, v47
  v_exp_f32 v48, v48
  v_exp_f32 v49, v49
  v_smfmac_f32_32x32x32_bf16 v[64:79], v[24:27], v[40:47], v231
  s_waitcnt lgkmcnt(0)
  v_exp_f32 v50, v50
  v_exp_f32 v51, v51
  v_exp_f32 v52, v52
  v_mfma_f32_32x32x16_bf16 v[32:47], v[16:19], v[8:11], 0.15915494
  s_add_u32 m0, s74, 8192
  s_add_u32 s75, s73, 65536
  buffer_load_dwordx4 v247, s[40:43], s75 offen lds
  v_exp_f32 v53, v53
  v_exp_f32 v54, v54
  v_exp_f32 v55, v55
  v_exp_f32 v56, v56
  v_exp_f32 v57, v57
  v_smfmac_f32_32x32x32_bf16 v[80:95], v[20:23], v[48:55], v231
  ds_read_b128 v[20:23], v241 offset:37440
  v_exp_f32 v58, v58
  v_exp_f32 v59, v59
  v_exp_f32 v60, v60
  v_exp_f32 v61, v61
  v_exp_f32 v62, v62
  v_exp_f32 v63, v63
  v_exp_f32 v32, v32
  v_exp_f32 v33, v33
  v_smfmac_f32_32x32x32_bf16 v[80:95], v[24:27], v[56:63], v231
  ds_read_b128 v[24:27], v242 offset:37440
  v_exp_f32 v34, v34
  v_exp_f32 v35, v35
  v_exp_f32 v36, v36
  v_mfma_f32_32x32x16_bf16 v[48:63], v[16:19], v[12:15], 0.15915494
  s_waitcnt lgkmcnt(1)
  ds_read_b128 v[16:19], v240 offset:39520
  v_exp_f32 v37, v37
  v_exp_f32 v38, v38
  v_exp_f32 v39, v39
  v_exp_f32 v40, v40
  v_exp_f32 v41, v41
  v_smfmac_f32_32x32x32_bf16 v[64:79], v[20:23], v[32:39], v231
  s_waitcnt lgkmcnt(1)
  v_exp_f32 v42, v42
  v_exp_f32 v43, v43
  v_exp_f32 v44, v44
  v_exp_f32 v45, v45
  v_exp_f32 v46, v46
  v_exp_f32 v47, v47
  v_exp_f32 v48, v48
  v_exp_f32 v49, v49
  v_smfmac_f32_32x32x32_bf16 v[64:79], v[24:27], v[40:47], v231
  s_waitcnt lgkmcnt(0)
  v_exp_f32 v50, v50
  v_exp_f32 v51, v51
  v_exp_f32 v52, v52
  v_mfma_f32_32x32x16_bf16 v[32:47], v[16:19], v[8:11], 0.15915494
  s_add_u32 m0, s74, 16384
  s_add_u32 s75, s73, 131072
  buffer_load_dwordx4 v247, s[40:43], s75 offen lds
  v_exp_f32 v53, v53
  v_exp_f32 v54, v54
  v_exp_f32 v55, v55
  v_exp_f32 v56, v56
  v_exp_f32 v57, v57
  v_smfmac_f32_32x32x32_bf16 v[80:95], v[20:23], v[48:55], v231
  ds_read_b128 v[20:23], v241 offset:39520
  v_exp_f32 v58, v58
  v_exp_f32 v59, v59
  v_exp_f32 v60, v60
  v_exp_f32 v61, v61
  v_exp_f32 v62, v62
  v_exp_f32 v63, v63
  v_exp_f32 v32, v32
  v_exp_f32 v33, v33
  v_smfmac_f32_32x32x32_bf16 v[80:95], v[24:27], v[56:63], v231
  ds_read_b128 v[24:27], v242 offset:39520
  v_exp_f32 v34, v34
  v_exp_f32 v35, v35
  v_exp_f32 v36, v36
  v_mfma_f32_32x32x16_bf16 v[48:63], v[16:19], v[12:15], 0.15915494
  s_waitcnt lgkmcnt(1)
  ds_read_b128 v[16:19], v240 offset:41600
  v_exp_f32 v37, v37
  v_exp_f32 v38, v38
  v_exp_f32 v39, v39
  v_exp_f32 v40, v40
  v_exp_f32 v41, v41
  v_smfmac_f32_32x32x32_bf16 v[64:79], v[20:23], v[32:39], v231
  s_waitcnt lgkmcnt(1)
  v_exp_f32 v42, v42
  v_exp_f32 v43, v43
  v_exp_f32 v44, v44
  v_exp_f32 v45, v45
  v_exp_f32 v46, v46
  v_exp_f32 v47, v47
  v_exp_f32 v48, v48
  v_exp_f32 v49, v49
  v_smfmac_f32_32x32x32_bf16 v[64:79], v[24:27], v[40:47], v231
  s_waitcnt lgkmcnt(0)
  v_exp_f32 v50, v50
  v_exp_f32 v51, v51
  v_exp_f32 v52, v52
  v_mfma_f32_32x32x16_bf16 v[32:47], v[16:19], v[8:11], 0.15915494
  s_add_u32 m0, s74, 24576
  s_add_u32 s75, s73, 196608
  buffer_load_dwordx4 v247, s[40:43], s75 offen lds
  v_exp_f32 v53, v53
  v_exp_f32 v54, v54
  v_exp_f32 v55, v55
  v_exp_f32 v56, v56
  v_exp_f32 v57, v57
  v_smfmac_f32_32x32x32_bf16 v[80:95], v[20:23], v[48:55], v231
  ds_read_b128 v[20:23], v241 offset:41600
  v_exp_f32 v58, v58
  v_exp_f32 v59, v59
  v_exp_f32 v60, v60
  v_exp_f32 v61, v61
  v_exp_f32 v62, v62
  v_exp_f32 v63, v63
  v_exp_f32 v32, v32
  v_exp_f32 v33, v33
  v_smfmac_f32_32x32x32_bf16 v[80:95], v[24:27], v[56:63], v231
  ds_read_b128 v[24:27], v242 offset:41600
  v_exp_f32 v34, v34
  v_exp_f32 v35, v35
  v_exp_f32 v36, v36
  v_mfma_f32_32x32x16_bf16 v[48:63], v[16:19], v[12:15], 0.15915494
  s_waitcnt lgkmcnt(1)
  s_setprio 2
  ds_read_b128 v[16:19], v240 offset:43680
  v_exp_f32 v37, v37
  v_exp_f32 v38, v38
  v_exp_f32 v39, v39
  v_exp_f32 v40, v40
  v_exp_f32 v41, v41
  v_smfmac_f32_32x32x32_bf16 v[64:79], v[20:23], v[32:39], v231
  s_waitcnt lgkmcnt(1)
  v_exp_f32 v42, v42
  v_exp_f32 v43, v43
  v_exp_f32 v44, v44
  v_exp_f32 v45, v45
  v_exp_f32 v46, v46
  v_exp_f32 v47, v47
  v_exp_f32 v48, v48
  v_exp_f32 v49, v49
  v_smfmac_f32_32x32x32_bf16 v[64:79], v[24:27], v[40:47], v231
  s_waitcnt lgkmcnt(0)
  v_exp_f32 v50, v50
  v_exp_f32 v51, v51
  v_exp_f32 v52, v52
  v_mfma_f32_32x32x16_bf16 v[32:47], v[16:19], v[8:11], 0.15915494
  buffer_load_dword v250, v253, s[36:39], s3 offen sc1
  buffer_load_dword v251, v253, s[36:39], s3 offen offset:128 sc1
  v_exp_f32 v53, v53
  v_exp_f32 v54, v54
  v_exp_f32 v55, v55
  v_exp_f32 v56, v56
  v_exp_f32 v57, v57
  v_smfmac_f32_32x32x32_bf16 v[80:95], v[20:23], v[48:55], v231
  ds_read_b128 v[20:23], v241 offset:43680
  v_exp_f32 v58, v58
  v_exp_f32 v59, v59
  v_exp_f32 v60, v60
  v_exp_f32 v61, v61
  v_exp_f32 v62, v62
  v_exp_f32 v63, v63
  v_exp_f32 v32, v32
  v_exp_f32 v33, v33
  v_smfmac_f32_32x32x32_bf16 v[80:95], v[24:27], v[56:63], v231
  ds_read_b128 v[24:27], v242 offset:43680
  v_exp_f32 v34, v34
  v_exp_f32 v35, v35
  v_exp_f32 v36, v36
  v_mfma_f32_32x32x16_bf16 v[48:63], v[16:19], v[12:15], 0.15915494
  s_waitcnt lgkmcnt(1)
  ds_read_b128 v[16:19], v240 offset:45760
  v_exp_f32 v37, v37
  v_exp_f32 v38, v38
  v_exp_f32 v39, v39
  v_exp_f32 v40, v40
  v_exp_f32 v41, v41
  v_smfmac_f32_32x32x32_bf16 v[64:79], v[20:23], v[32:39], v231
  s_waitcnt lgkmcnt(1)
  v_exp_f32 v42, v42
  v_exp_f32 v43, v43
  v_exp_f32 v44, v44
  v_exp_f32 v45, v45
  v_exp_f32 v46, v46
  v_exp_f32 v47, v47
  v_exp_f32 v48, v48
  v_exp_f32 v49, v49
  v_smfmac_f32_32x32x32_bf16 v[64:79], v[24:27], v[40:47], v231
  s_waitcnt lgkmcnt(0)
  v_exp_f32 v50, v50
  v_exp_f32 v51, v51
  v_exp_f32 v52, v52
  v_mfma_f32_32x32x16_bf16 v[32:47], v[16:19], v[8:11], 0.15915494
  s_setprio 1
  v_exp_f32 v53, v53
  v_exp_f32 v54, v54
  v_exp_f32 v55, v55
  v_exp_f32 v56, v56
  v_exp_f32 v57, v57
  v_smfmac_f32_32x32x32_bf16 v[80:95], v[20:23], v[48:55], v231
  ds_read_b128 v[20:23], v241 offset:45760
  v_exp_f32 v58, v58
  v_exp_f32 v59, v59
  v_exp_f32 v60, v60
  v_exp_f32 v61, v61
  v_exp_f32 v62, v62
  v_exp_f32 v63, v63
  v_exp_f32 v32, v32
  v_exp_f32 v33, v33
  v_smfmac_f32_32x32x32_bf16 v[80:95], v[24:27], v[56:63], v231
  ds_read_b128 v[24:27], v242 offset:45760
  v_exp_f32 v34, v34
  v_exp_f32 v35, v35
  v_exp_f32 v36, v36
  v_mfma_f32_32x32x16_bf16 v[48:63], v[16:19], v[12:15], 0.15915494
  s_waitcnt lgkmcnt(1)
  ds_read_b128 v[16:19], v240 offset:47840
  v_exp_f32 v37, v37
  v_exp_f32 v38, v38
  v_exp_f32 v39, v39
  v_exp_f32 v40, v40
  v_exp_f32 v41, v41
  v_smfmac_f32_32x32x32_bf16 v[64:79], v[20:23], v[32:39], v231
  s_waitcnt lgkmcnt(1)
  v_exp_f32 v42, v42
  v_exp_f32 v43, v43
  v_exp_f32 v44, v44
  v_exp_f32 v45, v45
  v_exp_f32 v46, v46
  v_exp_f32 v47, v47
  v_exp_f32 v48, v48
  v_exp_f32 v49, v49
  v_smfmac_f32_32x32x32_bf16 v[64:79], v[24:27], v[40:47], v231
  s_waitcnt lgkmcnt(0)
  v_exp_f32 v50, v50
  v_exp_f32 v51, v51
  v_exp_f32 v52, v52
  v_mfma_f32_32x32x16_bf16 v[32:47], v[16:19], v[8:11], 0.15915494
  s_setprio 0
  v_exp_f32 v53, v53
  v_exp_f32 v54, v54
  v_exp_f32 v55, v55
  v_exp_f32 v56, v56
  v_exp_f32 v57, v57
  v_smfmac_f32_32x32x32_bf16 v[80:95], v[20:23], v[48:55], v231
  ds_read_b128 v[20:23], v241 offset:47840
  v_exp_f32 v58, v58
  v_exp_f32 v59, v59
  v_exp_f32 v60, v60
  v_exp_f32 v61, v61
  v_exp_f32 v62, v62
  v_exp_f32 v63, v63
  v_exp_f32 v32, v32
  v_exp_f32 v33, v33
  v_smfmac_f32_32x32x32_bf16 v[80:95], v[24:27], v[56:63], v231
  ds_read_b128 v[24:27], v242 offset:47840
  v_exp_f32 v34, v34
  v_exp_f32 v35, v35
  v_exp_f32 v36, v36
  v_mfma_f32_32x32x16_bf16 v[48:63], v[16:19], v[12:15], 0.15915494
  s_waitcnt lgkmcnt(1)
  v_exp_f32 v37, v37
  v_exp_f32 v38, v38
  v_exp_f32 v39, v39
  v_exp_f32 v40, v40
  v_exp_f32 v41, v41
  v_smfmac_f32_32x32x32_bf16 v[64:79], v[20:23], v[32:39], v231
  s_waitcnt lgkmcnt(0)
  s_setprio 3
  s_waitcnt vmcnt(6)
  s_barrier
  ds_read_b128 v[16:19], v243 offset:0
  v_exp_f32 v42, v42
  v_exp_f32 v43, v43
  v_exp_f32 v44, v44
  v_exp_f32 v45, v45
  v_exp_f32 v46, v46
  v_exp_f32 v47, v47
  v_exp_f32 v48, v48
  v_exp_f32 v49, v49
  v_smfmac_f32_32x32x32_bf16 v[64:79], v[24:27], v[40:47], v231
  s_waitcnt lgkmcnt(0)
  v_exp_f32 v50, v50
  v_exp_f32 v51, v51
  v_exp_f32 v52, v52
  v_mfma_f32_32x32x16_bf16 v[32:47], v[16:19], v[8:11], 0.15915494
  v_exp_f32 v53, v53
  v_exp_f32 v54, v54
  v_exp_f32 v55, v55
  v_exp_f32 v56, v56
  v_exp_f32 v57, v57
  v_smfmac_f32_32x32x32_bf16 v[80:95], v[20:23], v[48:55], v231
  ds_read_b128 v[20:23], v244 offset:0
  v_exp_f32 v58, v58
  v_exp_f32 v59, v59
  v_exp_f32 v60, v60
  v_exp_f32 v61, v61
  v_exp_f32 v62, v62
  v_exp_f32 v63, v63
  v_exp_f32 v32, v32
  v_exp_f32 v33, v33
  v_smfmac_f32_32x32x32_bf16 v[80:95], v[24:27], v[56:63], v231
  ds_read_b128 v[24:27], v245 offset:0
  v_exp_f32 v34, v34
  v_exp_f32 v35, v35
  v_exp_f32 v36, v36
  v_mfma_f32_32x32x16_bf16 v[48:63], v[16:19], v[12:15], 0.15915494
  s_waitcnt lgkmcnt(1)
  ds_read_b128 v[16:19], v243 offset:2080
  v_exp_f32 v37, v37
  v_exp_f32 v38, v38
  v_exp_f32 v39, v39
  v_exp_f32 v40, v40
  v_exp_f32 v41, v41
  v_smfmac_f32_32x32x32_bf16 v[64:79], v[20:23], v[32:39], v231
  s_waitcnt lgkmcnt(1)
  v_exp_f32 v42, v42
  v_exp_f32 v43, v43
  v_exp_f32 v44, v44
  v_exp_f32 v45, v45
  v_exp_f32 v46, v46
  v_exp_f32 v47, v47
  v_exp_f32 v48, v48
  v_exp_f32 v49, v49
  v_smfmac_f32_32x32x32_bf16 v[64:79], v[24:27], v[40:47], v231
  s_waitcnt lgkmcnt(0)
  v_exp_f32 v50, v50
  v_exp_f32 v51, v51
  v_exp_f32 v52, v52
  v_mfma_f32_32x32x16_bf16 v[32:47], v[16:19], v[8:11], 0.15915494
  s_add_u32 m0, s74, 32768
  s_add_u32 s75, s73, 262144
  buffer_load_dwordx4 v247, s[40:43], s75 offen lds
  v_exp_f32 v53, v53
  v_exp_f32 v54, v54
  v_exp_f32 v55, v55
  v_exp_f32 v56, v56
  v_exp_f32 v57, v57
  v_smfmac_f32_32x32x32_bf16 v[80:95], v[20:23], v[48:55], v231
  ds_read_b128 v[20:23], v244 offset:2080
  v_exp_f32 v58, v58
  v_exp_f32 v59, v59
  v_exp_f32 v60, v60
  v_exp_f32 v61, v61
  v_exp_f32 v62, v62
  v_exp_f32 v63, v63
  v_exp_f32 v32, v32
  v_exp_f32 v33, v33
  v_smfmac_f32_32x32x32_bf16 v[80:95], v[24:27], v[56:63], v231
  ds_read_b128 v[24:27], v245 offset:2080
  v_exp_f32 v34, v34
  v_exp_f32 v35, v35
  v_exp_f32 v36, v36
  v_mfma_f32_32x32x16_bf16 v[48:63], v[16:19], v[12:15], 0.15915494
  s_waitcnt lgkmcnt(1)
  ds_read_b128 v[16:19], v243 offset:4160
  v_exp_f32 v37, v37
  v_exp_f32 v38, v38
  v_exp_f32 v39, v39
  v_exp_f32 v40, v40
  v_exp_f32 v41, v41
  v_smfmac_f32_32x32x32_bf16 v[64:79], v[20:23], v[32:39], v231
  s_waitcnt lgkmcnt(1)
  v_exp_f32 v42, v42
  v_exp_f32 v43, v43
  v_exp_f32 v44, v44
  v_exp_f32 v45, v45
  v_exp_f32 v46, v46
  v_exp_f32 v47, v47
  v_exp_f32 v48, v48
  v_exp_f32 v49, v49
  v_smfmac_f32_32x32x32_bf16 v[64:79], v[24:27], v[40:47], v231
  s_waitcnt lgkmcnt(0)
  v_exp_f32 v50, v50
  v_exp_f32 v51, v51
  v_exp_f32 v52, v52
  v_mfma_f32_32x32x16_bf16 v[32:47], v[16:19], v[8:11], 0.15915494
  s_add_u32 m0, s74, 40960
  s_add_u32 s75, s73, 327680
  buffer_load_dwordx4 v247, s[40:43], s75 offen lds
  v_exp_f32 v53, v53
  v_exp_f32 v54, v54
  v_exp_f32 v55, v55
  v_exp_f32 v56, v56
  v_exp_f32 v57, v57
  v_smfmac_f32_32x32x32_bf16 v[80:95], v[20:23], v[48:55], v231
  ds_read_b128 v[20:23], v244 offset:4160
  v_exp_f32 v58, v58
  v_exp_f32 v59, v59
  v_exp_f32 v60, v60
  v_exp_f32 v61, v61
  v_exp_f32 v62, v62
  v_exp_f32 v63, v63
  v_exp_f32 v32, v32
  v_exp_f32 v33, v33
  v_smfmac_f32_32x32x32_bf16 v[80:95], v[24:27], v[56:63], v231
  ds_read_b128 v[24:27], v245 offset:4160
  v_exp_f32 v34, v34
  v_exp_f32 v35, v35
  v_exp_f32 v36, v36
  v_mfma_f32_32x32x16_bf16 v[48:63], v[16:19], v[12:15], 0.15915494
  s_waitcnt lgkmcnt(1)
  ds_read_b128 v[16:19], v243 offset:6240
  v_exp_f32 v37, v37
  v_exp_f32 v38, v38
  v_exp_f32 v39, v39
  v_exp_f32 v40, v40
  v_exp_f32 v41, v41
  v_smfmac_f32_32x32x32_bf16 v[64:79], v[20:23], v[32:39], v231
  s_waitcnt lgkmcnt(1)
  v_exp_f32 v42, v42
  v_exp_f32 v43, v43
  v_exp_f32 v44, v44
  v_exp_f32 v45, v45
  v_exp_f32 v46, v46
  v_exp_f32 v47, v47
  v_exp_f32 v48, v48
  v_exp_f32 v49, v49
  v_smfmac_f32_32x32x32_bf16 v[64:79], v[24:27], v[40:47], v231
  s_waitcnt lgkmcnt(0)
  v_exp_f32 v50, v50
  v_exp_f32 v51, v51
  v_exp_f32 v52, v52
  v_mfma_f32_32x32x16_bf16 v[32:47], v[16:19], v[8:11], 0.15915494
  s_barrier
  s_add_u32 m0, s74, 49152
  s_add_u32 s75, s73, 393216
  buffer_load_dwordx4 v247, s[40:43], s75 offen lds
  v_exp_f32 v53, v53
  v_exp_f32 v54, v54
  v_exp_f32 v55, v55
  v_exp_f32 v56, v56
  v_exp_f32 v57, v57
  v_smfmac_f32_32x32x32_bf16 v[80:95], v[20:23], v[48:55], v231
  ds_read_b128 v[20:23], v244 offset:6240
  v_exp_f32 v58, v58
  v_exp_f32 v59, v59
  v_exp_f32 v60, v60
  v_exp_f32 v61, v61
  v_exp_f32 v62, v62
  v_exp_f32 v63, v63
  v_exp_f32 v32, v32
  v_exp_f32 v33, v33
  v_smfmac_f32_32x32x32_bf16 v[80:95], v[24:27], v[56:63], v231
  ds_read_b128 v[24:27], v245 offset:6240
  v_exp_f32 v34, v34
  v_exp_f32 v35, v35
  v_exp_f32 v36, v36
  v_mfma_f32_32x32x16_bf16 v[48:63], v[16:19], v[12:15], 0.15915494
  s_waitcnt lgkmcnt(1)
  ds_read_b128 v[16:19], v243 offset:8320
  v_exp_f32 v37, v37
  v_exp_f32 v38, v38
  v_exp_f32 v39, v39
  v_exp_f32 v40, v40
  v_exp_f32 v41, v41
  v_smfmac_f32_32x32x32_bf16 v[64:79], v[20:23], v[32:39], v231
  s_waitcnt lgkmcnt(1)
  v_exp_f32 v42, v42
  v_exp_f32 v43, v43
  v_exp_f32 v44, v44
  v_exp_f32 v45, v45
  v_exp_f32 v46, v46
  v_exp_f32 v47, v47
  v_exp_f32 v48, v48
  v_exp_f32 v49, v49
  v_smfmac_f32_32x32x32_bf16 v[64:79], v[24:27], v[40:47], v231
  s_waitcnt lgkmcnt(0)
  v_exp_f32 v50, v50
  v_exp_f32 v51, v51
  v_exp_f32 v52, v52
  v_mfma_f32_32x32x16_bf16 v[32:47], v[16:19], v[8:11], 0.15915494
  s_add_u32 m0, s74, 57344
  s_add_u32 s75, s73, 458752
  buffer_load_dwordx4 v247, s[40:43], s75 offen lds
  v_exp_f32 v53, v53
  v_exp_f32 v54, v54
  v_exp_f32 v55, v55
  v_exp_f32 v56, v56
  v_exp_f32 v57, v57
  v_smfmac_f32_32x32x32_bf16 v[80:95], v[20:23], v[48:55], v231
  ds_read_b128 v[20:23], v244 offset:8320
  v_exp_f32 v58, v58
  v_exp_f32 v59, v59
  v_exp_f32 v60, v60
  v_exp_f32 v61, v61
  v_exp_f32 v62, v62
  v_exp_f32 v63, v63
  v_exp_f32 v32, v32
  v_exp_f32 v33, v33
  v_smfmac_f32_32x32x32_bf16 v[80:95], v[24:27], v[56:63], v231
  ds_read_b128 v[24:27], v245 offset:8320
  v_exp_f32 v34, v34
  v_exp_f32 v35, v35
  v_exp_f32 v36, v36
  v_mfma_f32_32x32x16_bf16 v[48:63], v[16:19], v[12:15], 0.15915494
  s_waitcnt lgkmcnt(1)
  s_setprio 2
  ds_read_b128 v[16:19], v243 offset:10400
  v_exp_f32 v37, v37
  v_exp_f32 v38, v38
  v_exp_f32 v39, v39
  v_exp_f32 v40, v40
  v_exp_f32 v41, v41
  v_smfmac_f32_32x32x32_bf16 v[64:79], v[20:23], v[32:39], v231
  s_waitcnt lgkmcnt(1)
  v_exp_f32 v42, v42
  v_exp_f32 v43, v43
  v_exp_f32 v44, v44
  v_exp_f32 v45, v45
  v_exp_f32 v46, v46
  v_exp_f32 v47, v47
  v_exp_f32 v48, v48
  v_exp_f32 v49, v49
  v_smfmac_f32_32x32x32_bf16 v[64:79], v[24:27], v[40:47], v231
  s_waitcnt lgkmcnt(0)
  v_exp_f32 v50, v50
  v_exp_f32 v51, v51
  v_exp_f32 v52, v52
  v_mfma_f32_32x32x16_bf16 v[32:47], v[16:19], v[8:11], 0.15915494
  s_add_u32 m0, s74, 65536
  s_add_u32 s75, s73, 0
  buffer_load_dwordx4 v247, s[44:47], s75 offen lds
  v_exp_f32 v53, v53
  v_exp_f32 v54, v54
  v_exp_f32 v55, v55
  v_exp_f32 v56, v56
  v_exp_f32 v57, v57
  v_smfmac_f32_32x32x32_bf16 v[80:95], v[20:23], v[48:55], v231
  ds_read_b128 v[20:23], v244 offset:10400
  v_exp_f32 v58, v58
  v_exp_f32 v59, v59
  v_exp_f32 v60, v60
  v_exp_f32 v61, v61
  v_exp_f32 v62, v62
  v_exp_f32 v63, v63
  v_exp_f32 v32, v32
  v_exp_f32 v33, v33
  v_smfmac_f32_32x32x32_bf16 v[80:95], v[24:27], v[56:63], v231
  ds_read_b128 v[24:27], v245 offset:10400
  v_exp_f32 v34, v34
  v_exp_f32 v35, v35
  v_exp_f32 v36, v36
  v_mfma_f32_32x32x16_bf16 v[48:63], v[16:19], v[12:15], 0.15915494
  s_waitcnt lgkmcnt(1)
  ds_read_b128 v[16:19], v243 offset:12480
  v_exp_f32 v37, v37
  v_exp_f32 v38, v38
  v_exp_f32 v39, v39
  v_exp_f32 v40, v40
  v_exp_f32 v41, v41
  v_smfmac_f32_32x32x32_bf16 v[64:79], v[20:23], v[32:39], v231
  s_waitcnt lgkmcnt(1)
  v_exp_f32 v42, v42
  v_exp_f32 v43, v43
  v_exp_f32 v44, v44
  v_exp_f32 v45, v45
  v_exp_f32 v46, v46
  v_exp_f32 v47, v47
  v_exp_f32 v48, v48
  v_exp_f32 v49, v49
  v_smfmac_f32_32x32x32_bf16 v[64:79], v[24:27], v[40:47], v231
  s_waitcnt lgkmcnt(0)
  v_exp_f32 v50, v50
  v_exp_f32 v51, v51
  v_exp_f32 v52, v52
  v_mfma_f32_32x32x16_bf16 v[32:47], v[16:19], v[8:11], 0.15915494
  s_setprio 1
  s_add_u32 m0, s74, 122880
  s_add_u32 s75, s73, 458752
  buffer_load_dwordx4 v247, s[44:47], s75 offen lds
  v_exp_f32 v53, v53
  v_exp_f32 v54, v54
  v_exp_f32 v55, v55
  v_exp_f32 v56, v56
  v_exp_f32 v57, v57
  v_smfmac_f32_32x32x32_bf16 v[80:95], v[20:23], v[48:55], v231
  ds_read_b128 v[20:23], v244 offset:12480
  v_exp_f32 v58, v58
  v_exp_f32 v59, v59
  v_exp_f32 v60, v60
  v_exp_f32 v61, v61
  v_exp_f32 v62, v62
  v_exp_f32 v63, v63
  v_exp_f32 v32, v32
  v_exp_f32 v33, v33
  v_smfmac_f32_32x32x32_bf16 v[80:95], v[24:27], v[56:63], v231
  ds_read_b128 v[24:27], v245 offset:12480
  v_exp_f32 v34, v34
  v_exp_f32 v35, v35
  v_exp_f32 v36, v36
  v_mfma_f32_32x32x16_bf16 v[48:63], v[16:19], v[12:15], 0.15915494
  s_waitcnt lgkmcnt(1)
  ds_read_b128 v[16:19], v243 offset:14560
  v_exp_f32 v37, v37
  v_exp_f32 v38, v38
  v_exp_f32 v39, v39
  v_exp_f32 v40, v40
  v_exp_f32 v41, v41
  v_smfmac_f32_32x32x32_bf16 v[64:79], v[20:23], v[32:39], v231
  s_waitcnt lgkmcnt(1)
  v_exp_f32 v42, v42
  v_exp_f32 v43, v43
  v_exp_f32 v44, v44
  v_exp_f32 v45, v45
  v_exp_f32 v46, v46
  v_exp_f32 v47, v47
  v_exp_f32 v48, v48
  v_exp_f32 v49, v49
  v_smfmac_f32_32x32x32_bf16 v[64:79], v[24:27], v[40:47], v231
  s_waitcnt lgkmcnt(0)
  v_exp_f32 v50, v50
  v_exp_f32 v51, v51
  v_exp_f32 v52, v52
  v_mfma_f32_32x32x16_bf16 v[32:47], v[16:19], v[8:11], 0.15915494
  s_setprio 0
  v_exp_f32 v53, v53
  v_exp_f32 v54, v54
  v_exp_f32 v55, v55
  v_exp_f32 v56, v56
  v_exp_f32 v57, v57
  v_smfmac_f32_32x32x32_bf16 v[80:95], v[20:23], v[48:55], v231
  ds_read_b128 v[20:23], v244 offset:14560
  v_exp_f32 v58, v58
  v_exp_f32 v59, v59
  v_exp_f32 v60, v60
  v_exp_f32 v61, v61
  v_exp_f32 v62, v62
  v_exp_f32 v63, v63
  v_exp_f32 v32, v32
  v_exp_f32 v33, v33
  v_smfmac_f32_32x32x32_bf16 v[80:95], v[24:27], v[56:63], v231
  ds_read_b128 v[24:27], v245 offset:14560
  v_exp_f32 v34, v34
  v_exp_f32 v35, v35
  v_exp_f32 v36, v36
  v_mfma_f32_32x32x16_bf16 v[48:63], v[16:19], v[12:15], 0.15915494
  s_waitcnt lgkmcnt(1)
  v_exp_f32 v37, v37
  v_exp_f32 v38, v38
  v_exp_f32 v39, v39
  v_exp_f32 v40, v40
  v_exp_f32 v41, v41
  v_smfmac_f32_32x32x32_bf16 v[64:79], v[20:23], v[32:39], v231
  s_waitcnt lgkmcnt(0)
  v_exp_f32 v42, v42
  v_exp_f32 v43, v43
  v_exp_f32 v44, v44
  v_exp_f32 v45, v45
  v_exp_f32 v46, v46
  v_exp_f32 v47, v47
  v_exp_f32 v48, v48
  v_exp_f32 v49, v49
  v_smfmac_f32_32x32x32_bf16 v[64:79], v[24:27], v[40:47], v231
  s_waitcnt lgkmcnt(0)
  v_exp_f32 v50, v50
  v_exp_f32 v51, v51
  v_exp_f32 v52, v52
  v_exp_f32 v53, v53
  v_exp_f32 v54, v54
  v_exp_f32 v55, v55
  v_exp_f32 v56, v56
  v_exp_f32 v57, v57
  v_smfmac_f32_32x32x32_bf16 v[80:95], v[20:23], v[48:55], v231
  v_exp_f32 v58, v58
  v_exp_f32 v59, v59
  v_exp_f32 v60, v60
  v_exp_f32 v61, v61
  v_exp_f32 v62, v62
  v_exp_f32 v63, v63
  s_nop 1
  v_smfmac_f32_32x32x32_bf16 v[80:95], v[24:27], v[56:63], v231
  s_mov_b32 s64, 0x33800000
  s_mov_b32 s65, 0x5f800000
  s_mov_b32 s66, 0x7f800000
  s_mov_b64 s[68:69], 0
  v_add_f32 v104, |v64|, |v65|
  v_add_f32 v105, |v66|, |v67|
  v_add_f32 v106, |v68|, |v69|
  v_add_f32 v107, |v70|, |v71|
  v_add_f32 v104, v104, v105
  v_add_f32 v106, v106, v107
  v_add_f32 v104, v104, v106
  v_cmp_nle_f32 vcc, s64, v72
  s_or_b64 s[68:69], s[68:69], vcc
  v_cmp_nge_f32 vcc, s65, v72
  s_or_b64 s[68:69], s[68:69], vcc
  v_cmp_ngt_f32 vcc, s66, v104
  s_or_b64 s[68:69], s[68:69], vcc
  s_nop 1
  v_add_f32 v104, |v80|, |v81|
  v_add_f32 v105, |v82|, |v83|
  v_add_f32 v106, |v84|, |v85|
  v_add_f32 v107, |v86|, |v87|
  v_add_f32 v104, v104, v105
  v_add_f32 v106, v106, v107
  v_add_f32 v104, v104, v106
  v_cmp_nle_f32 vcc, s64, v88
  s_or_b64 s[68:69], s[68:69], vcc
  v_cmp_nge_f32 vcc, s65, v88
  s_or_b64 s[68:69], s[68:69], vcc
  v_cmp_ngt_f32 vcc, s66, v104
  s_or_b64 s[68:69], s[68:69], vcc
  s_cmp_lg_u64 s[68:69], 0
  s_cbranch_scc1 L_slow
L_slow_ret:
  s_add_u32 s75, s4, 65536
  s_mov_b32 s62, 0xfffffffe
  s_waitcnt vmcnt(6)
  v_sub_f32 v250, s7, v250
  v_sub_f32 v251, s7, v251
  v_rcp_f32 v104, v72
  v_rcp_f32 v106, v88
  v_mul_f32 v104, v104, |v250|
  v_mov_b32 v105, v104
  v_pk_mul_f32 v[64:65], v[64:65], v[104:105]
  v_pk_mul_f32 v[66:67], v[66:67], v[104:105]
  v_pk_mul_f32 v[68:69], v[68:69], v[104:105]
  v_pk_mul_f32 v[70:71], v[70:71], v[104:105]
  v_cvt_pk_bf16_f32 v108, v64, v65
  v_cvt_pk_bf16_f32 v109, v66, v67
  v_cvt_pk_bf16_f32 v110, v68, v69
  v_cvt_pk_bf16_f32 v111, v70, v71
  v_min_u32 v108, s62, v108
  v_min_u32 v109, s62, v109
  v_min_u32 v110, s62, v110
  v_min_u32 v111, s62, v111
  buffer_store_dwordx4 v[108:111], v246, s[36:39], s4 offen sc1
  v_mul_f32 v106, v106, |v251|
  v_mov_b32 v107, v106
  v_pk_mul_f32 v[80:81], v[80:81], v[106:107]
  v_pk_mul_f32 v[82:83], v[82:83], v[106:107]
  v_pk_mul_f32 v[84:85], v[84:85], v[106:107]
  v_pk_mul_f32 v[86:87], v[86:87], v[106:107]
  v_cvt_pk_bf16_f32 v112, v80, v81
  v_cvt_pk_bf16_f32 v113, v82, v83
  v_cvt_pk_bf16_f32 v114, v84, v85
  v_cvt_pk_bf16_f32 v115, v86, v87
  v_min_u32 v112, s62, v112
  v_min_u32 v113, s62, v113
  v_min_u32 v114, s62, v114
  v_min_u32 v115, s62, v115
  buffer_store_dwordx4 v[112:115], v246, s[36:39], s75 offen sc1
  s_cmp_ge_u32 s56, 4
  s_cbranch_scc1 L_p3_idle
  s_add_u32 s8, s5, 0
  s_add_u32 s9, s5, 4096
  s_add_u32 s10, s5, 8192
  s_add_u32 s11, s5, 12288
  s_add_u32 s12, s5, 16384
  s_add_u32 s13, s5, 20480
  s_add_u32 s14, s5, 24576
  s_add_u32 s15, s5, 28672
  s_mov_b32 s61, 200000
  v_mov_b32 v4, v246
  v_lshrrev_b32 v16, 5, v0
  v_lshlrev_b32 v16, 2, v16
  v_bfe_u32 v17, v0, 2, 2
  v_add_u32 v16, v16, v17
  v_lshlrev_b32 v16, 7, v16
  v_bfe_u32 v17, v0, 4, 1
  v_lshlrev_b32 v17, 1, v17
  v_bfe_u32 v18, v0, 1, 1
  v_add_u32 v17, v17, v18
  v_bfe_u32 v18, v0, 3, 1
  v_lshlrev_b32 v18, 2, v18
  v_xor_b32 v17, v17, v18
  v_lshl_add_u32 v16, v17, 4, v16
  v_and_b32 v17, 1, v0
  v_lshl_add_u32 v16, v17, 3, v16
  s_lshr_b32 s66, s56, 1
  s_lshl_b32 s67, s66, 16
  s_add_u32 s67, s67, 0
  v_add_u32 v2, s67, v16
  v_xor_b32 v3, 64, v2
  v_xor_b32 v20, 0x8000, v2
  v_xor_b32 v21, 0x8000, v3
  v_and_b32 v16, 31, v0
  s_and_b32 s62, s56, 1
  s_lshl_b32 s62, s62, 13
  s_lshl_b32 s63, s66, 14
  s_add_u32 s62, s62, s63
  s_add_u32 s62, s62, 131072
  v_lshlrev_b32 v16, 8, v16
  v_lshrrev_b32 v17, 5, v0
  v_and_b32 v18, 7, v0
  v_xor_b32 v17, v17, v18
  v_lshl_add_u32 v16, v17, 4, v16
  v_add_u32 v12, s62, v16
  v_xor_b32 v13, 32, v12
  v_xor_b32 v14, 64, v12
  v_xor_b32 v15, 96, v12
  s_waitcnt vmcnt(2)
  s_barrier
  buffer_load_dwordx4 v[128:131], v4, s[36:39], s8 offen offset:0 sc1
  buffer_load_dwordx4 v[132:135], v4, s[36:39], s8 offen offset:1024 sc1
  buffer_load_dwordx4 v[136:139], v4, s[36:39], s8 offen offset:2048 sc1
  buffer_load_dwordx4 v[140:143], v4, s[36:39], s8 offen offset:3072 sc1
  buffer_load_dwordx4 v[144:147], v4, s[36:39], s9 offen offset:0 sc1
  buffer_load_dwordx4 v[148:151], v4, s[36:39], s9 offen offset:1024 sc1
  buffer_load_dwordx4 v[152:155], v4, s[36:39], s9 offen offset:2048 sc1
  buffer_load_dwordx4 v[156:159], v4, s[36:39], s9 offen offset:3072 sc1
  ds_read_b64_tr_b16 v[64:65], v2 offset:0
  ds_read_b64_tr_b16 v[66:67], v2 offset:1024
  ds_read_b64_tr_b16 v[68:69], v3 offset:0
  ds_read_b64_tr_b16 v[70:71], v3 offset:1024
  ds_read_b64_tr_b16 v[72:73], v2 offset:2048
  ds_read_b64_tr_b16 v[74:75], v2 offset:3072
  ds_read_b64_tr_b16 v[76:77], v3 offset:2048
  ds_read_b64_tr_b16 v[78:79], v3 offset:3072
L_ostep0:
  s_waitcnt vmcnt(7)
  v_max3_u32 v10, v128, v129, v130
  v_max_u32 v10, v10, v131
  v_cmp_eq_u32 vcc, -1, v10
  s_waitcnt lgkmcnt(4)
  s_cbranch_vccnz L_oretry0
L_ogo0:
  v_mfma_f32_32x32x16_bf16 v[32:47], v[64:67], v[128:131], 0
  buffer_load_dwordx4 v[160:163], v4, s[36:39], s10 offen offset:0 sc1
L_ostep1:
  s_waitcnt vmcnt(7)
  v_max3_u32 v10, v132, v133, v134
  v_max_u32 v10, v10, v135
  v_cmp_eq_u32 vcc, -1, v10
  v_mfma_f32_32x32x16_bf16 v[48:63], v[68:71], v[128:131], 0
  ds_read_b64_tr_b16 v[80:81], v2 offset:4096
  ds_read_b64_tr_b16 v[82:83], v2 offset:5120
  ds_read_b64_tr_b16 v[84:85], v3 offset:4096
  ds_read_b64_tr_b16 v[86:87], v3 offset:5120
  s_waitcnt lgkmcnt(4)
  s_cbranch_vccnz L_oretry1
L_ogo1:
  v_mfma_f32_32x32x16_bf16 v[32:47], v[72:75], v[132:135], v[32:47]
  buffer_load_dwordx4 v[164:167], v4, s[36:39], s10 offen offset:1024 sc1
L_ostep2:
  s_waitcnt vmcnt(7)
  v_max3_u32 v10, v136, v137, v138
  v_max_u32 v10, v10, v139
  v_cmp_eq_u32 vcc, -1, v10
  v_mfma_f32_32x32x16_bf16 v[48:63], v[76:79], v[132:135], v[48:63]
  ds_read_b64_tr_b16 v[88:89], v2 offset:6144
  ds_read_b64_tr_b16 v[90:91], v2 offset:7168
  ds_read_b64_tr_b16 v[92:93], v3 offset:6144
  ds_read_b64_tr_b16 v[94:95], v3 offset:7168
  s_waitcnt lgkmcnt(4)
  s_cbranch_vccnz L_oretry2
L_ogo2:
  v_mfma_f32_32x32x16_bf16 v[32:47], v[80:83], v[136:139], v[32:47]
  buffer_load_dwordx4 v[168:171], v4, s[36:39], s10 offen offset:2048 sc1
L_ostep3:
  s_waitcnt vmcnt(7)
  v_max3_u32 v10, v140, v141, v142
  v_max_u32 v10, v10, v143
  v_cmp_eq_u32 vcc, -1, v10
  v_mfma_f32_32x32x16_bf16 v[48:63], v[84:87], v[136:139], v[48:63]
  ds_read_b64_tr_b16 v[64:65], v2 offset:8192
  ds_read_b64_tr_b16 v[66:67], v2 offset:9216
  ds_read_b64_tr_b16 v[68:69], v3 offset:8192
  ds_read_b64_tr_b16 v[70:71], v3 offset:9216
  s_waitcnt lgkmcnt(4)
  s_cbranch_vccnz L_oretry3
L_ogo3:
  v_mfma_f32_32x32x16_bf16 v[32:47], v[88:91], v[140:143], v[32:47]
  buffer_load_dwordx4 v[172:175], v4, s[36:39], s10 offen offset:3072 sc1
L_ostep4:
  s_waitcnt vmcnt(7)
  v_max3_u32 v10, v144, v145, v146
  v_max_u32 v10, v10, v147
  v_cmp_eq_u32 vcc, -1, v10
  v_mfma_f32_32x32x16_bf16 v[48:63], v[92:95], v[140:143], v[48:63]
  ds_read_b64_tr_b16 v[72:73], v2 offset:10240
  ds_read_b64_tr_b16 v[74:75], v2 offset:11264
  ds_read_b64_tr_b16 v[76:77], v3 offset:10240
  ds_read_b64_tr_b16 v[78:79], v3 offset:11264
  s_waitcnt lgkmcnt(4)
  s_cbranch_vccnz L_oretry4
L_ogo4:
  v_mfma_f32_32x32x16_bf16 v[32:47], v[64:67], v[144:147], v[32:47]
  buffer_load_dwordx4 v[176:179], v4, s[36:39], s11 offen offset:0 sc1
L_ostep5:
  s_waitcnt vmcnt(7)
  v_max3_u32 v10, v148, v149, v150
  v_max_u32 v10, v10, v151
  v_cmp_eq_u32 vcc, -1, v10
  v_mfma_f32_32x32x16_bf16 v[48:63], v[68:71], v[144:147], v[48:63]
  ds_read_b64_tr_b16 v[80:81], v2 offset:12288
  ds_read_b64_tr_b16 v[82:83], v2 offset:13312
  ds_read_b64_tr_b16 v[84:85], v3 offset:12288
  ds_read_b64_tr_b16 v[86:87], v3 offset:13312
  s_waitcnt lgkmcnt(4)
  s_cbranch_vccnz L_oretry5
L_ogo5:
  v_mfma_f32_32x32x16_bf16 v[32:47], v[72:75], v[148:151], v[32:47]
  buffer_load_dwordx4 v[180:183], v4, s[36:39], s11 offen offset:1024 sc1
L_ostep6:
  s_waitcnt vmcnt(7)
  v_max3_u32 v10, v152, v153, v154
  v_max_u32 v10, v10, v155
  v_cmp_eq_u32 vcc, -1, v10
  v_mfma_f32_32x32x16_bf16 v[48:63], v[76:79], v[148:151], v[48:63]
  ds_read_b64_tr_b16 v[88:89], v2 offset:14336
  ds_read_b64_tr_b16 v[90:91], v2 offset:15360
  ds_read_b64_tr_b16 v[92:93], v3 offset:14336
  ds_read_b64_tr_b16 v[94:95], v3 offset:15360
  s_waitcnt lgkmcnt(4)
  s_cbranch_vccnz L_oretry6
L_ogo6:
  v_mfma_f32_32x32x16_bf16 v[32:47], v[80:83], v[152:155], v[32:47]
  buffer_load_dwordx4 v[184:187], v4, s[36:39], s11 offen offset:2048 sc1
L_ostep7:
  s_waitcnt vmcnt(7)
  v_max3_u32 v10, v156, v157, v158
  v_max_u32 v10, v10, v159
  v_cmp_eq_u32 vcc, -1, v10
  v_mfma_f32_32x32x16_bf16 v[48:63], v[84:87], v[152:155], v[48:63]
  ds_read_b64_tr_b16 v[64:65], v2 offset:16384
  ds_read_b64_tr_b16 v[66:67], v2 offset:17408
  ds_read_b64_tr_b16 v[68:69], v3 offset:16384
  ds_read_b64_tr_b16 v[70:71], v3 offset:17408
  s_waitcnt lgkmcnt(4)
  s_cbranch_vccnz L_oretry7
L_ogo7:
  v_mfma_f32_32x32x16_bf16 v[32:47], v[88:91], v[156:159], v[32:47]
  buffer_load_dwordx4 v[188:191], v4, s[36:39], s11 offen offset:3072 sc1
L_ostep8:
  s_waitcnt vmcnt(7)
  v_max3_u32 v10, v160, v161, v162
  v_max_u32 v10, v10, v163
  v_cmp_eq_u32 vcc, -1, v10
  v_mfma_f32_32x32x16_bf16 v[48:63], v[92:95], v[156:159], v[48:63]
  ds_read_b64_tr_b16 v[72:73], v2 offset:18432
  ds_read_b64_tr_b16 v[74:75], v2 offset:19456
  ds_read_b64_tr_b16 v[76:77], v3 offset:18432
  ds_read_b64_tr_b16 v[78:79], v3 offset:19456
  s_waitcnt lgkmcnt(4)
  s_cbranch_vccnz L_oretry8
L_ogo8:
  v_mfma_f32_32x32x16_bf16 v[32:47], v[64:67], v[160:163], v[32:47]
  buffer_load_dwordx4 v[128:131], v4, s[36:39], s12 offen offset:0 sc1
L_ostep9:
  s_waitcnt vmcnt(7)
  v_max3_u32 v10, v164, v165, v166
  v_max_u32 v10, v10, v167
  v_cmp_eq_u32 vcc, -1, v10
  v_mfma_f32_32x32x16_bf16 v[48:63], v[68:71], v[160:163], v[48:63]
  ds_read_b64_tr_b16 v[80:81], v2 offset:20480
  ds_read_b64_tr_b16 v[82:83], v2 offset:21504
  ds_read_b64_tr_b16 v[84:85], v3 offset:20480
  ds_read_b64_tr_b16 v[86:87], v3 offset:21504
  s_waitcnt lgkmcnt(4)
  s_cbranch_vccnz L_oretry9
L_ogo9:
  v_mfma_f32_32x32x16_bf16 v[32:47], v[72:75], v[164:167], v[32:47]
  buffer_load_dwordx4 v[132:135], v4, s[36:39], s12 offen offset:1024 sc1
L_ostep10:
  s_waitcnt vmcnt(7)
  v_max3_u32 v10, v168, v169, v170
  v_max_u32 v10, v10, v171
  v_cmp_eq_u32 vcc, -1, v10
  v_mfma_f32_32x32x16_bf16 v[48:63], v[76:79], v[164:167], v[48:63]
  ds_read_b64_tr_b16 v[88:89], v2 offset:22528
  ds_read_b64_tr_b16 v[90:91], v2 offset:23552
  ds_read_b64_tr_b16 v[92:93], v3 offset:22528
  ds_read_b64_tr_b16 v[94:95], v3 offset:23552
  s_waitcnt lgkmcnt(4)
  s_cbranch_vccnz L_oretry10
L_ogo10:
  v_mfma_f32_32x32x16_bf16 v[32:47], v[80:83], v[168:171], v[32:47]
  buffer_load_dwordx4 v[136:139], v4, s[36:39], s12 offen offset:2048 sc1
L_ostep11:
  s_waitcnt vmcnt(7)
  v_max3_u32 v10, v172, v173, v174
  v_max_u32 v10, v10, v175
  v_cmp_eq_u32 vcc, -1, v10
  v_mfma_f32_32x32x16_bf16 v[48:63], v[84:87], v[168:171], v[48:63]
  ds_read_b64_tr_b16 v[64:65], v2 offset:24576
  ds_read_b64_tr_b16 v[66:67], v2 offset:25600
  ds_read_b64_tr_b16 v[68:69], v3 offset:24576
  ds_read_b64_tr_b16 v[70:71], v3 offset:25600
  s_waitcnt lgkmcnt(4)
  s_cbranch_vccnz L_oretry11
L_ogo11:
  v_mfma_f32_32x32x16_bf16 v[32:47], v[88:91], v[172:175], v[32:47]
  buffer_load_dwordx4 v[140:143], v4, s[36:39], s12 offen offset:3072 sc1
L_ostep12:
  s_waitcnt vmcnt(7)
  v_max3_u32 v10, v176, v177, v178
  v_max_u32 v10, v10, v179
  v_cmp_eq_u32 vcc, -1, v10
  v_mfma_f32_32x32x16_bf16 v[48:63], v[92:95], v[172:175], v[48:63]
  ds_read_b64_tr_b16 v[72:73], v2 offset:26624
  ds_read_b64_tr_b16 v[74:75], v2 offset:27648
  ds_read_b64_tr_b16 v[76:77], v3 offset:26624
  ds_read_b64_tr_b16 v[78:79], v3 offset:27648
  s_waitcnt lgkmcnt(4)
  s_cbranch_vccnz L_oretry12
L_ogo12:
  v_mfma_f32_32x32x16_bf16 v[32:47], v[64:67], v[176:179], v[32:47]
  buffer_load_dwordx4 v[144:147], v4, s[36:39], s13 offen offset:0 sc1
L_ostep13:
  s_waitcnt vmcnt(7)
  v_max3_u32 v10, v180, v181, v182
  v_max_u32 v10, v10, v183
  v_cmp_eq_u32 vcc, -1, v10
  v_mfma_f32_32x32x16_bf16 v[48:63], v[68:71], v[176:179], v[48:63]
  ds_read_b64_tr_b16 v[80:81], v2 offset:28672
  ds_read_b64_tr_b16 v[82:83], v2 offset:29696
  ds_read_b64_tr_b16 v[84:85], v3 offset:28672
  ds_read_b64_tr_b16 v[86:87], v3 offset:29696
  s_waitcnt lgkmcnt(4)
  s_cbranch_vccnz L_oretry13
L_ogo13:
  v_mfma_f32_32x32x16_bf16 v[32:47], v[72:75], v[180:183], v[32:47]
  buffer_load_dwordx4 v[148:151], v4, s[36:39], s13 offen offset:1024 sc1
L_ostep14:
  s_waitcnt vmcnt(7)
  v_max3_u32 v10, v184, v185, v186
  v_max_u32 v10, v10, v187
  v_cmp_eq_u32 vcc, -1, v10
  v_mfma_f32_32x32x16_bf16 v[48:63], v[76:79], v[180:183], v[48:63]
  ds_read_b64_tr_b16 v[88:89], v2 offset:30720
  ds_read_b64_tr_b16 v[90:91], v2 offset:31744
  ds_read_b64_tr_b16 v[92:93], v3 offset:30720
  ds_read_b64_tr_b16 v[94:95], v3 offset:31744
  s_waitcnt lgkmcnt(4)
  s_cbranch_vccnz L_oretry14
L_ogo14:
  v_mfma_f32_32x32x16_bf16 v[32:47], v[80:83], v[184:187], v[32:47]
  buffer_load_dwordx4 v[152:155], v4, s[36:39], s13 offen offset:2048 sc1
L_ostep15:
  s_waitcnt vmcnt(7)
  v_max3_u32 v10, v188, v189, v190
  v_max_u32 v10, v10, v191
  v_cmp_eq_u32 vcc, -1, v10
  v_mfma_f32_32x32x16_bf16 v[48:63], v[84:87], v[184:187], v[48:63]
  ds_read_b64_tr_b16 v[64:65], v20 offset:0
  ds_read_b64_tr_b16 v[66:67], v20 offset:1024
  ds_read_b64_tr_b16 v[68:69], v21 offset:0
  ds_read_b64_tr_b16 v[70:71], v21 offset:1024
  s_waitcnt lgkmcnt(4)
  s_cbranch_vccnz L_oretry15
L_ogo15:
  v_mfma_f32_32x32x16_bf16 v[32:47], v[88:91], v[188:191], v[32:47]
  buffer_load_dwordx4 v[156:159], v4, s[36:39], s13 offen offset:3072 sc1
L_ostep16:
  s_waitcnt vmcnt(7)
  v_max3_u32 v10, v128, v129, v130
  v_max_u32 v10, v10, v131
  v_cmp_eq_u32 vcc, -1, v10
  v_mfma_f32_32x32x16_bf16 v[48:63], v[92:95], v[188:191], v[48:63]
  ds_read_b64_tr_b16 v[72:73], v20 offset:2048
  ds_read_b64_tr_b16 v[74:75], v20 offset:3072
  ds_read_b64_tr_b16 v[76:77], v21 offset:2048
  ds_read_b64_tr_b16 v[78:79], v21 offset:3072
  s_waitcnt lgkmcnt(4)
  s_cbranch_vccnz L_oretry16
L_ogo16:
  v_mfma_f32_32x32x16_bf16 v[32:47], v[64:67], v[128:131], v[32:47]
  buffer_load_dwordx4 v[160:163], v4, s[36:39], s14 offen offset:0 sc1
L_ostep17:
  s_waitcnt vmcnt(7)
  v_max3_u32 v10, v132, v133, v134
  v_max_u32 v10, v10, v135
  v_cmp_eq_u32 vcc, -1, v10
  v_mfma_f32_32x32x16_bf16 v[48:63], v[68:71], v[128:131], v[48:63]
  ds_read_b64_tr_b16 v[80:81], v20 offset:4096
  ds_read_b64_tr_b16 v[82:83], v20 offset:5120
  ds_read_b64_tr_b16 v[84:85], v21 offset:4096
  ds_read_b64_tr_b16 v[86:87], v21 offset:5120
  s_waitcnt lgkmcnt(4)
  s_cbranch_vccnz L_oretry17
L_ogo17:
  v_mfma_f32_32x32x16_bf16 v[32:47], v[72:75], v[132:135], v[32:47]
  buffer_load_dwordx4 v[164:167], v4, s[36:39], s14 offen offset:1024 sc1
L_ostep18:
  s_waitcnt vmcnt(7)
  v_max3_u32 v10, v136, v137, v138
  v_max_u32 v10, v10, v139
  v_cmp_eq_u32 vcc, -1, v10
  v_mfma_f32_32x32x16_bf16 v[48:63], v[76:79], v[132:135], v[48:63]
  ds_read_b64_tr_b16 v[88:89], v20 offset:6144
  ds_read_b64_tr_b16 v[90:91], v20 offset:7168
  ds_read_b64_tr_b16 v[92:93], v21 offset:6144
  ds_read_b64_tr_b16 v[94:95], v21 offset:7168
  s_waitcnt lgkmcnt(4)
  s_cbranch_vccnz L_oretry18
L_ogo18:
  v_mfma_f32_32x32x16_bf16 v[32:47], v[80:83], v[136:139], v[32:47]
  buffer_load_dwordx4 v[168:171], v4, s[36:39], s14 offen offset:2048 sc1
L_ostep19:
  s_waitcnt vmcnt(7)
  v_max3_u32 v10, v140, v141, v142
  v_max_u32 v10, v10, v143
  v_cmp_eq_u32 vcc, -1, v10
  v_mfma_f32_32x32x16_bf16 v[48:63], v[84:87], v[136:139], v[48:63]
  ds_read_b64_tr_b16 v[64:65], v20 offset:8192
  ds_read_b64_tr_b16 v[66:67], v20 offset:9216
  ds_read_b64_tr_b16 v[68:69], v21 offset:8192
  ds_read_b64_tr_b16 v[70:71], v21 offset:9216
  s_waitcnt lgkmcnt(4)
  s_cbranch_vccnz L_oretry19
L_ogo19:
  v_mfma_f32_32x32x16_bf16 v[32:47], v[88:91], v[140:143], v[32:47]
  buffer_load_dwordx4 v[172:175], v4, s[36:39], s14 offen offset:3072 sc1
L_ostep20:
  s_waitcnt vmcnt(7)
  v_max3_u32 v10, v144, v145, v146
  v_max_u32 v10, v10, v147
  v_cmp_eq_u32 vcc, -1, v10
  v_mfma_f32_32x32x16_bf16 v[48:63], v[92:95], v[140:143], v[48:63]
  ds_read_b64_tr_b16 v[72:73], v20 offset:10240
  ds_read_b64_tr_b16 v[74:75], v20 offset:11264
  ds_read_b64_tr_b16 v[76:77], v21 offset:10240
  ds_read_b64_tr_b16 v[78:79], v21 offset:11264
  s_waitcnt lgkmcnt(4)
  s_cbranch_vccnz L_oretry20
L_ogo20:
  v_mfma_f32_32x32x16_bf16 v[32:47], v[64:67], v[144:147], v[32:47]
  buffer_load_dwordx4 v[176:179], v4, s[36:39], s15 offen offset:0 sc1
L_ostep21:
  s_waitcnt vmcnt(7)
  v_max3_u32 v10, v148, v149, v150
  v_max_u32 v10, v10, v151
  v_cmp_eq_u32 vcc, -1, v10
  v_mfma_f32_32x32x16_bf16 v[48:63], v[68:71], v[144:147], v[48:63]
  ds_read_b64_tr_b16 v[80:81], v20 offset:12288
  ds_read_b64_tr_b16 v[82:83], v20 offset:13312
  ds_read_b64_tr_b16 v[84:85], v21 offset:12288
  ds_read_b64_tr_b16 v[86:87], v21 offset:13312
  s_waitcnt lgkmcnt(4)
  s_cbranch_vccnz L_oretry21
L_ogo21:
  v_mfma_f32_32x32x16_bf16 v[32:47], v[72:75], v[148:151], v[32:47]
  buffer_load_dwordx4 v[180:183], v4, s[36:39], s15 offen offset:1024 sc1
L_ostep22:
  s_waitcnt vmcnt(7)
  v_max3_u32 v10, v152, v153, v154
  v_max_u32 v10, v10, v155
  v_cmp_eq_u32 vcc, -1, v10
  v_mfma_f32_32x32x16_bf16 v[48:63], v[76:79], v[148:151], v[48:63]
  ds_read_b64_tr_b16 v[88:89], v20 offset:14336
  ds_read_b64_tr_b16 v[90:91], v20 offset:15360
  ds_read_b64_tr_b16 v[92:93], v21 offset:14336
  ds_read_b64_tr_b16 v[94:95], v21 offset:15360
  s_waitcnt lgkmcnt(4)
  s_cbranch_vccnz L_oretry22
L_ogo22:
  v_mfma_f32_32x32x16_bf16 v[32:47], v[80:83], v[152:155], v[32:47]
  buffer_load_dwordx4 v[184:187], v4, s[36:39], s15 offen offset:2048 sc1
L_ostep23:
  s_waitcnt vmcnt(7)
  v_max3_u32 v10, v156, v157, v158
  v_max_u32 v10, v10, v159
  v_cmp_eq_u32 vcc, -1, v10
  v_mfma_f32_32x32x16_bf16 v[48:63], v[84:87], v[152:155], v[48:63]
  ds_read_b64_tr_b16 v[64:65], v20 offset:16384
  ds_read_b64_tr_b16 v[66:67], v20 offset:17408
  ds_read_b64_tr_b16 v[68:69], v21 offset:16384
  ds_read_b64_tr_b16 v[70:71], v21 offset:17408
  s_waitcnt lgkmcnt(4)
  s_cbranch_vccnz L_oretry23
L_ogo23:
  v_mfma_f32_32x32x16_bf16 v[32:47], v[88:91], v[156:159], v[32:47]
  buffer_load_dwordx4 v[188:191], v4, s[36:39], s15 offen offset:3072 sc1
L_ostep24:
  s_waitcnt vmcnt(7)
  v_max3_u32 v10, v160, v161, v162
  v_max_u32 v10, v10, v163
  v_cmp_eq_u32 vcc, -1, v10
  v_mfma_f32_32x32x16_bf16 v[48:63], v[92:95], v[156:159], v[48:63]
  ds_read_b64_tr_b16 v[72:73], v20 offset:18432
  ds_read_b64_tr_b16 v[74:75], v20 offset:19456
  ds_read_b64_tr_b16 v[76:77], v21 offset:18432
  ds_read_b64_tr_b16 v[78:79], v21 offset:19456
  s_waitcnt lgkmcnt(4)
  s_cbranch_vccnz L_oretry24
L_ogo24:
  v_mfma_f32_32x32x16_bf16 v[32:47], v[64:67], v[160:163], v[32:47]
L_ostep25:
  s_waitcnt vmcnt(6)
  v_max3_u32 v10, v164, v165, v166
  v_max_u32 v10, v10, v167
  v_cmp_eq_u32 vcc, -1, v10
  v_mfma_f32_32x32x16_bf16 v[48:63], v[68:71], v[160:163], v[48:63]
  ds_read_b64_tr_b16 v[80:81], v20 offset:20480
  ds_read_b64_tr_b16 v[82:83], v20 offset:21504
  ds_read_b64_tr_b16 v[84:85], v21 offset:20480
  ds_read_b64_tr_b16 v[86:87], v21 offset:21504
  s_waitcnt lgkmcnt(4)
  s_cbranch_vccnz L_oretry25
L_ogo25:
  v_mfma_f32_32x32x16_bf16 v[32:47], v[72:75], v[164:167], v[32:47]
L_ostep26:
  s_waitcnt vmcnt(5)
  v_max3_u32 v10, v168, v169, v170
  v_max_u32 v10, v10, v171
  v_cmp_eq_u32 vcc, -1, v10
  v_mfma_f32_32x32x16_bf16 v[48:63], v[76:79], v[164:167], v[48:63]
  ds_read_b64_tr_b16 v[88:89], v20 offset:22528
  ds_read_b64_tr_b16 v[90:91], v20 offset:23552
  ds_read_b64_tr_b16 v[92:93], v21 offset:22528
  ds_read_b64_tr_b16 v[94:95], v21 offset:23552
  s_waitcnt lgkmcnt(4)
  s_cbranch_vccnz L_oretry26
L_ogo26:
  v_mfma_f32_32x32x16_bf16 v[32:47], v[80:83], v[168:171], v[32:47]
L_ostep27:
  s_waitcnt vmcnt(4)
  v_max3_u32 v10, v172, v173, v174
  v_max_u32 v10, v10, v175
  v_cmp_eq_u32 vcc, -1, v10
  v_mfma_f32_32x32x16_bf16 v[48:63], v[84:87], v[168:171], v[48:63]
  ds_read_b64_tr_b16 v[64:65], v20 offset:24576
  ds_read_b64_tr_b16 v[66:67], v20 offset:25600
  ds_read_b64_tr_b16 v[68:69], v21 offset:24576
  ds_read_b64_tr_b16 v[70:71], v21 offset:25600
  s_waitcnt lgkmcnt(4)
  s_cbranch_vccnz L_oretry27
L_ogo27:
  v_mfma_f32_32x32x16_bf16 v[32:47], v[88:91], v[172:175], v[32:47]
L_ostep28:
  s_waitcnt vmcnt(3)
  v_max3_u32 v10, v176, v177, v178
  v_max_u32 v10, v10, v179
  v_cmp_eq_u32 vcc, -1, v10
  v_mfma_f32_32x32x16_bf16 v[48:63], v[92:95], v[172:175], v[48:63]
  ds_read_b64_tr_b16 v[72:73], v20 offset:26624
  ds_read_b64_tr_b16 v[74:75], v20 offset:27648
  ds_read_b64_tr_b16 v[76:77], v21 offset:26624
  ds_read_b64_tr_b16 v[78:79], v21 offset:27648
  s_waitcnt lgkmcnt(4)
  s_cbranch_vccnz L_oretry28
L_ogo28:
  v_mfma_f32_32x32x16_bf16 v[32:47], v[64:67], v[176:179], v[32:47]
L_ostep29:
  s_waitcnt vmcnt(2)
  v_max3_u32 v10, v180, v181, v182
  v_max_u32 v10, v10, v183
  v_cmp_eq_u32 vcc, -1, v10
  v_mfma_f32_32x32x16_bf16 v[48:63], v[68:71], v[176:179], v[48:63]
  ds_read_b64_tr_b16 v[80:81], v20 offset:28672
  ds_read_b64_tr_b16 v[82:83], v20 offset:29696
  ds_read_b64_tr_b16 v[84:85], v21 offset:28672
  ds_read_b64_tr_b16 v[86:87], v21 offset:29696
  s_waitcnt lgkmcnt(4)
  s_cbranch_vccnz L_oretry29
L_ogo29:
  v_mfma_f32_32x32x16_bf16 v[32:47], v[72:75], v[180:183], v[32:47]
L_ostep30:
  s_waitcnt vmcnt(1)
  v_max3_u32 v10, v184, v185, v186
  v_max_u32 v10, v10, v187
  v_cmp_eq_u32 vcc, -1, v10
  v_mfma_f32_32x32x16_bf16 v[48:63], v[76:79], v[180:183], v[48:63]
  ds_read_b64_tr_b16 v[88:89], v20 offset:30720
  ds_read_b64_tr_b16 v[90:91], v20 offset:31744
  ds_read_b64_tr_b16 v[92:93], v21 offset:30720
  ds_read_b64_tr_b16 v[94:95], v21 offset:31744
  s_waitcnt lgkmcnt(4)
  s_cbranch_vccnz L_oretry30
L_ogo30:
  v_mfma_f32_32x32x16_bf16 v[32:47], v[80:83], v[184:187], v[32:47]
L_ostep31:
  s_waitcnt vmcnt(0)
  v_max3_u32 v10, v188, v189, v190
  v_max_u32 v10, v10, v191
  v_cmp_eq_u32 vcc, -1, v10
  v_mfma_f32_32x32x16_bf16 v[48:63], v[84:87], v[184:187], v[48:63]
  s_waitcnt lgkmcnt(0)
  s_cbranch_vccnz L_oretry31
L_ogo31:
  v_mfma_f32_32x32x16_bf16 v[32:47], v[88:91], v[188:191], v[32:47]
  v_mfma_f32_32x32x16_bf16 v[48:63], v[92:95], v[188:191], v[48:63]
  s_nop 7
  s_nop 2
  ds_write_b128 v12, v[32:35] offset:0
  ds_write_b128 v13, v[36:39] offset:0
  ds_write_b128 v14, v[40:43] offset:0
  ds_write_b128 v15, v[44:47] offset:0
  ds_write_b128 v12, v[48:51] offset:128
  ds_write_b128 v13, v[52:55] offset:128
  ds_write_b128 v14, v[56:59] offset:128
  ds_write_b128 v15, v[60:63] offset:128
  s_branch L_p3_fin
L_p3_idle:
  s_waitcnt vmcnt(2)
  s_barrier
L_p3_fin:
  v_lshrrev_b32 v16, 3, v0
  s_lshl_b32 s62, s56, 3
  v_add_u32 v16, s62, v16
  v_and_b32 v17, 7, v0
  v_lshlrev_b32 v18, 1, v17
  v_and_b32 v19, 7, v16
  v_xor_b32 v18, v18, v19
  v_lshlrev_b32 v18, 4, v18
  v_lshl_add_u32 v7, v16, 8, v18
  v_add_u32 v7, 131072, v7
  v_xor_b32 v6, 16, v7
  v_lshlrev_b32 v16, 10, v16
  v_lshl_add_u32 v8, v17, 4, v16
  s_waitcnt lgkmcnt(0)
  s_barrier
  ds_read_b128 v[64:67], v7
  ds_read_b128 v[72:75], v7 offset:16384
  ds_read_b128 v[68:71], v6
  ds_read_b128 v[76:79], v6 offset:16384
  s_waitcnt lgkmcnt(2)
  v_pk_add_f32 v[64:65], v[64:65], v[72:73]
  v_pk_add_f32 v[66:67], v[66:67], v[74:75]
  s_waitcnt lgkmcnt(0)
  v_pk_add_f32 v[68:69], v[68:69], v[76:77]
  v_pk_add_f32 v[70:71], v[70:71], v[78:79]
  v_cvt_pk_bf16_f32 v96, v64, v65
  v_cvt_pk_bf16_f32 v97, v66, v67
  v_cvt_pk_bf16_f32 v98, v68, v69
  v_cvt_pk_bf16_f32 v99, v70, v71
  buffer_store_dwordx4 v[96:99], v8, s[48:51], s6 offen sc0 sc1
L_end:
  s_endpgm
L_spin_z:
  s_mov_b32 s61, 200000
L_spinl_z:
  s_sleep 4
  buffer_load_dword v252, off, s[52:55], s13 sc1
  s_sub_u32 s61, s61, 1
  s_cbranch_scc1 L_ret_z
  s_waitcnt vmcnt(0)
  v_cmp_gt_u32 vcc, 8, v252
  s_nop 0
  s_cbranch_vccnz L_spinl_z
  s_branch L_ret_z
L_spin_f1:
  s_mov_b32 s61, 200000
L_spinl_f1:
  buffer_load_dword v249, v248, s[36:39], s79 offen sc1
  s_sub_u32 s61, s61, 1
  s_cbranch_scc1 L_ret_f1
  s_waitcnt vmcnt(0)
  v_cmp_ne_u32 vcc, 1, v249
  s_nop 0
  s_cbranch_vccnz L_spinl_f1
  s_branch L_ret_f1
L_spin_z2:
  s_mov_b32 s61, 200000
L_spinl_z2:
  s_sleep 4
  buffer_load_dword v255, v254, s[52:55], 0 offen offset:4 sc1
  s_sub_u32 s61, s61, 1
  s_cbranch_scc1 L_ret_z2
  s_waitcnt vmcnt(0)
  v_cmp_gt_u32 vcc, s75, v255
  s_nop 0
  s_cbranch_vccnz L_spinl_z2
  s_branch L_ret_z2
L_slow:
  s_lshl_b32 s62, s58, 18
  s_lshr_b32 s63, s56, 2
  s_lshl_b32 s63, s63, 14
  s_add_u32 s62, s62, s63
  v_lshrrev_b32 v108, 5, v0
  v_and_b32 v109, 15, v0
  v_lshlrev_b32 v109, 4, v109
  v_lshl_add_u32 v109, v108, 8, v109
  v_and_b32 v108, 11, v0
  v_cmp_eq_u32 vcc, 0, v108
  v_mov_b32 v110, 0
  v_mov_b32 v111, 0x3f803f80
  v_cndmask_b32 v110, v110, v111, vcc
  v_mov_b32 v20, v110
  v_mov_b32 v21, v110
  v_mov_b32 v22, v110
  v_mov_b32 v23, v110
  v_mov_b32 v24, v110
  v_mov_b32 v25, v110
  v_mov_b32 v26, v110
  v_mov_b32 v27, v110
  v_mov_b32 v104, 0xff800000
  v_mov_b32 v64, 0
  v_mov_b32 v65, 0
  v_mov_b32 v66, 0
  v_mov_b32 v67, 0
  v_mov_b32 v68, 0
  v_mov_b32 v69, 0
  v_mov_b32 v70, 0
  v_mov_b32 v71, 0
  v_mov_b32 v72, 0
  v_mov_b32 v73, 0
  v_mov_b32 v74, 0
  v_mov_b32 v75, 0
  v_mov_b32 v76, 0
  v_mov_b32 v77, 0
  v_mov_b32 v78, 0
  v_mov_b32 v79, 0
  v_mov_b32 v105, 0xff800000
  v_mov_b32 v80, 0
  v_mov_b32 v81, 0
  v_mov_b32 v82, 0
  v_mov_b32 v83, 0
  v_mov_b32 v84, 0
  v_mov_b32 v85, 0
  v_mov_b32 v86, 0
  v_mov_b32 v87, 0
  v_mov_b32 v88, 0
  v_mov_b32 v89, 0
  v_mov_b32 v90, 0
  v_mov_b32 v91, 0
  v_mov_b32 v92, 0
  v_mov_b32 v93, 0
  v_mov_b32 v94, 0
  v_mov_b32 v95, 0
  s_mov_b32 s64, 0
L_slow_loop:
  s_lshr_b32 s65, s64, 3
  s_lshl_b32 s65, s65, 15
  s_and_b32 s66, s64, 7
  s_lshl_b32 s66, s66, 11
  s_add_u32 s65, s65, s66
  s_add_u32 s65, s65, s62
  buffer_load_dwordx4 v[16:19], v246, s[36:39], s65 offen sc1
  s_mov_b32 exec_lo, 0xffff
  s_mov_b32 exec_hi, 0xffff
  buffer_load_dwordx4 v[20:23], v109, s[36:39], s65 offen offset:1024 sc1
  buffer_load_dwordx4 v[24:27], v109, s[36:39], s65 offen offset:1536 sc1
  s_mov_b64 exec, -1
  s_waitcnt vmcnt(0)
  v_mfma_f32_32x32x16_bf16 v[32:47], v[16:19], v[8:11], 0
  s_nop 15
  s_nop 3
  v_max3_f32 v107, v32, v33, v104
  v_max3_f32 v107, v34, v35, v107
  v_max3_f32 v107, v36, v37, v107
  v_max3_f32 v107, v38, v39, v107
  v_max3_f32 v107, v40, v41, v107
  v_max3_f32 v107, v42, v43, v107
  v_max3_f32 v107, v44, v45, v107
  v_max3_f32 v107, v46, v47, v107
  v_mov_b32 v108, v107
  s_nop 1
  v_permlane32_swap_b32 v107, v108
  v_max_f32 v107, v107, v108
  v_sub_f32 v106, v104, v107
  v_exp_f32 v106, v106
  v_mov_b32 v104, v107
  v_sub_f32 v32, v32, v107
  v_sub_f32 v33, v33, v107
  v_sub_f32 v34, v34, v107
  v_sub_f32 v35, v35, v107
  v_sub_f32 v36, v36, v107
  v_sub_f32 v37, v37, v107
  v_sub_f32 v38, v38, v107
  v_sub_f32 v39, v39, v107
  v_sub_f32 v40, v40, v107
  v_sub_f32 v41, v41, v107
  v_sub_f32 v42, v42, v107
  v_sub_f32 v43, v43, v107
  v_sub_f32 v44, v44, v107
  v_sub_f32 v45, v45, v107
  v_sub_f32 v46, v46, v107
  v_sub_f32 v47, v47, v107
  v_exp_f32 v32, v32
  v_exp_f32 v33, v33
  v_exp_f32 v34, v34
  v_exp_f32 v35, v35
  v_exp_f32 v36, v36
  v_exp_f32 v37, v37
  v_exp_f32 v38, v38
  v_exp_f32 v39, v39
  v_exp_f32 v40, v40
  v_exp_f32 v41, v41
  v_exp_f32 v42, v42
  v_exp_f32 v43, v43
  v_exp_f32 v44, v44
  v_exp_f32 v45, v45
  v_exp_f32 v46, v46
  v_exp_f32 v47, v47
  v_mul_f32 v64, v64, v106
  v_mul_f32 v65, v65, v106
  v_mul_f32 v66, v66, v106
  v_mul_f32 v67, v67, v106
  v_mul_f32 v68, v68, v106
  v_mul_f32 v69, v69, v106
  v_mul_f32 v70, v70, v106
  v_mul_f32 v71, v71, v106
  v_mul_f32 v72, v72, v106
  s_nop 1
  v_smfmac_f32_32x32x32_bf16 v[64:79], v[20:23], v[32:39], v231
  v_smfmac_f32_32x32x32_bf16 v[64:79], v[24:27], v[40:47], v231
  s_nop 15
  s_nop 3
  v_mfma_f32_32x32x16_bf16 v[48:63], v[16:19], v[12:15], 0
  s_nop 15
  s_nop 3
  v_max3_f32 v107, v48, v49, v105
  v_max3_f32 v107, v50, v51, v107
  v_max3_f32 v107, v52, v53, v107
  v_max3_f32 v107, v54, v55, v107
  v_max3_f32 v107, v56, v57, v107
  v_max3_f32 v107, v58, v59, v107
  v_max3_f32 v107, v60, v61, v107
  v_max3_f32 v107, v62, v63, v107
  v_mov_b32 v108, v107
  s_nop 1
  v_permlane32_swap_b32 v107, v108
  v_max_f32 v107, v107, v108
  v_sub_f32 v106, v105, v107
  v_exp_f32 v106, v106
  v_mov_b32 v105, v107
  v_sub_f32 v48, v48, v107
  v_sub_f32 v49, v49, v107
  v_sub_f32 v50, v50, v107
  v_sub_f32 v51, v51, v107
  v_sub_f32 v52, v52, v107
  v_sub_f32 v53, v53, v107
  v_sub_f32 v54, v54, v107
  v_sub_f32 v55, v55, v107
  v_sub_f32 v56, v56, v107
  v_sub_f32 v57, v57, v107
  v_sub_f32 v58, v58, v107
  v_sub_f32 v59, v59, v107
  v_sub_f32 v60, v60, v107
  v_sub_f32 v61, v61, v107
  v_sub_f32 v62, v62, v107
  v_sub_f32 v63, v63, v107
  v_exp_f32 v48, v48
  v_exp_f32 v49, v49
  v_exp_f32 v50, v50
  v_exp_f32 v51, v51
  v_exp_f32 v52, v52
  v_exp_f32 v53, v53
  v_exp_f32 v54, v54
  v_exp_f32 v55, v55
  v_exp_f32 v56, v56
  v_exp_f32 v57, v57
  v_exp_f32 v58, v58
  v_exp_f32 v59, v59
  v_exp_f32 v60, v60
  v_exp_f32 v61, v61
  v_exp_f32 v62, v62
  v_exp_f32 v63, v63
  v_mul_f32 v80, v80, v106
  v_mul_f32 v81, v81, v106
  v_mul_f32 v82, v82, v106
  v_mul_f32 v83, v83, v106
  v_mul_f32 v84, v84, v106
  v_mul_f32 v85, v85, v106
  v_mul_f32 v86, v86, v106
  v_mul_f32 v87, v87, v106
  v_mul_f32 v88, v88, v106
  s_nop 1
  v_smfmac_f32_32x32x32_bf16 v[80:95], v[20:23], v[48:55], v231
  v_smfmac_f32_32x32x32_bf16 v[80:95], v[24:27], v[56:63], v231
  s_nop 15
  s_nop 3
  s_add_u32 s64, s64, 1
  s_cmp_lt_u32 s64, 64
  s_cbranch_scc1 L_slow_loop
  s_branch L_slow_ret
L_oretry0:
  s_sub_u32 s61, s61, 1
  s_cmp_gt_i32 s61, 0
  s_cbranch_scc0 L_ogo0
  s_waitcnt vmcnt(0)
  buffer_load_dwordx4 v[128:131], v4, s[36:39], s8 offen offset:0 sc1
  buffer_load_dwordx4 v[132:135], v4, s[36:39], s8 offen offset:1024 sc1
  buffer_load_dwordx4 v[136:139], v4, s[36:39], s8 offen offset:2048 sc1
  buffer_load_dwordx4 v[140:143], v4, s[36:39], s8 offen offset:3072 sc1
  buffer_load_dwordx4 v[144:147], v4, s[36:39], s9 offen offset:0 sc1
  buffer_load_dwordx4 v[148:151], v4, s[36:39], s9 offen offset:1024 sc1
  buffer_load_dwordx4 v[152:155], v4, s[36:39], s9 offen offset:2048 sc1
  buffer_load_dwordx4 v[156:159], v4, s[36:39], s9 offen offset:3072 sc1
  s_waitcnt vmcnt(7)
  v_max3_u32 v10, v128, v129, v130
  v_max_u32 v10, v10, v131
  v_cmp_eq_u32 vcc, -1, v10
  s_nop 0
  s_cbranch_vccnz L_oretry0
  s_branch L_ogo0
L_oretry1:
  s_sub_u32 s61, s61, 1
  s_cmp_gt_i32 s61, 0
  s_cbranch_scc0 L_ogo1
  s_waitcnt vmcnt(0)
  buffer_load_dwordx4 v[132:135], v4, s[36:39], s8 offen offset:1024 sc1
  buffer_load_dwordx4 v[136:139], v4, s[36:39], s8 offen offset:2048 sc1
  buffer_load_dwordx4 v[140:143], v4, s[36:39], s8 offen offset:3072 sc1
  buffer_load_dwordx4 v[144:147], v4, s[36:39], s9 offen offset:0 sc1
  buffer_load_dwordx4 v[148:151], v4, s[36:39], s9 offen offset:1024 sc1
  buffer_load_dwordx4 v[152:155], v4, s[36:39], s9 offen offset:2048 sc1
  buffer_load_dwordx4 v[156:159], v4, s[36:39], s9 offen offset:3072 sc1
  buffer_load_dwordx4 v[160:163], v4, s[36:39], s10 offen offset:0 sc1
  s_waitcnt vmcnt(7)
  v_max3_u32 v10, v132, v133, v134
  v_max_u32 v10, v10, v135
  v_cmp_eq_u32 vcc, -1, v10
  s_nop 0
  s_cbranch_vccnz L_oretry1
  s_branch L_ogo1
L_oretry2:
  s_sub_u32 s61, s61, 1
  s_cmp_gt_i32 s61, 0
  s_cbranch_scc0 L_ogo2
  s_waitcnt vmcnt(0)
  buffer_load_dwordx4 v[136:139], v4, s[36:39], s8 offen offset:2048 sc1
  buffer_load_dwordx4 v[140:143], v4, s[36:39], s8 offen offset:3072 sc1
  buffer_load_dwordx4 v[144:147], v4, s[36:39], s9 offen offset:0 sc1
  buffer_load_dwordx4 v[148:151], v4, s[36:39], s9 offen offset:1024 sc1
  buffer_load_dwordx4 v[152:155], v4, s[36:39], s9 offen offset:2048 sc1
  buffer_load_dwordx4 v[156:159], v4, s[36:39], s9 offen offset:3072 sc1
  buffer_load_dwordx4 v[160:163], v4, s[36:39], s10 offen offset:0 sc1
  buffer_load_dwordx4 v[164:167], v4, s[36:39], s10 offen offset:1024 sc1
  s_waitcnt vmcnt(7)
  v_max3_u32 v10, v136, v137, v138
  v_max_u32 v10, v10, v139
  v_cmp_eq_u32 vcc, -1, v10
  s_nop 0
  s_cbranch_vccnz L_oretry2
  s_branch L_ogo2
L_oretry3:
  s_sub_u32 s61, s61, 1
  s_cmp_gt_i32 s61, 0
  s_cbranch_scc0 L_ogo3
  s_waitcnt vmcnt(0)
  buffer_load_dwordx4 v[140:143], v4, s[36:39], s8 offen offset:3072 sc1
  buffer_load_dwordx4 v[144:147], v4, s[36:39], s9 offen offset:0 sc1
  buffer_load_dwordx4 v[148:151], v4, s[36:39], s9 offen offset:1024 sc1
  buffer_load_dwordx4 v[152:155], v4, s[36:39], s9 offen offset:2048 sc1
  buffer_load_dwordx4 v[156:159], v4, s[36:39], s9 offen offset:3072 sc1
  buffer_load_dwordx4 v[160:163], v4, s[36:39], s10 offen offset:0 sc1
  buffer_load_dwordx4 v[164:167], v4, s[36:39], s10 offen offset:1024 sc1
  buffer_load_dwordx4 v[168:171], v4, s[36:39], s10 offen offset:2048 sc1
  s_waitcnt vmcnt(7)
  v_max3_u32 v10, v140, v141, v142
  v_max_u32 v10, v10, v143
  v_cmp_eq_u32 vcc, -1, v10
  s_nop 0
  s_cbranch_vccnz L_oretry3
  s_branch L_ogo3
L_oretry4:
  s_sub_u32 s61, s61, 1
  s_cmp_gt_i32 s61, 0
  s_cbranch_scc0 L_ogo4
  s_waitcnt vmcnt(0)
  buffer_load_dwordx4 v[144:147], v4, s[36:39], s9 offen offset:0 sc1
  buffer_load_dwordx4 v[148:151], v4, s[36:39], s9 offen offset:1024 sc1
  buffer_load_dwordx4 v[152:155], v4, s[36:39], s9 offen offset:2048 sc1
  buffer_load_dwordx4 v[156:159], v4, s[36:39], s9 offen offset:3072 sc1
  buffer_load_dwordx4 v[160:163], v4, s[36:39], s10 offen offset:0 sc1
  buffer_load_dwordx4 v[164:167], v4, s[36:39], s10 offen offset:1024 sc1
  buffer_load_dwordx4 v[168:171], v4, s[36:39], s10 offen offset:2048 sc1
  buffer_load_dwordx4 v[172:175], v4, s[36:39], s10 offen offset:3072 sc1
  s_waitcnt vmcnt(7)
  v_max3_u32 v10, v144, v145, v146
  v_max_u32 v10, v10, v147
  v_cmp_eq_u32 vcc, -1, v10
  s_nop 0
  s_cbranch_vccnz L_oretry4
  s_branch L_ogo4
L_oretry5:
  s_sub_u32 s61, s61, 1
  s_cmp_gt_i32 s61, 0
  s_cbranch_scc0 L_ogo5
  s_waitcnt vmcnt(0)
  buffer_load_dwordx4 v[148:151], v4, s[36:39], s9 offen offset:1024 sc1
  buffer_load_dwordx4 v[152:155], v4, s[36:39], s9 offen offset:2048 sc1
  buffer_load_dwordx4 v[156:159], v4, s[36:39], s9 offen offset:3072 sc1
  buffer_load_dwordx4 v[160:163], v4, s[36:39], s10 offen offset:0 sc1
  buffer_load_dwordx4 v[164:167], v4, s[36:39], s10 offen offset:1024 sc1
  buffer_load_dwordx4 v[168:171], v4, s[36:39], s10 offen offset:2048 sc1
  buffer_load_dwordx4 v[172:175], v4, s[36:39], s10 offen offset:3072 sc1
  buffer_load_dwordx4 v[176:179], v4, s[36:39], s11 offen offset:0 sc1
  s_waitcnt vmcnt(7)
  v_max3_u32 v10, v148, v149, v150
  v_max_u32 v10, v10, v151
  v_cmp_eq_u32 vcc, -1, v10
  s_nop 0
  s_cbranch_vccnz L_oretry5
  s_branch L_ogo5
L_oretry6:
  s_sub_u32 s61, s61, 1
  s_cmp_gt_i32 s61, 0
  s_cbranch_scc0 L_ogo6
  s_waitcnt vmcnt(0)
  buffer_load_dwordx4 v[152:155], v4, s[36:39], s9 offen offset:2048 sc1
  buffer_load_dwordx4 v[156:159], v4, s[36:39], s9 offen offset:3072 sc1
  buffer_load_dwordx4 v[160:163], v4, s[36:39], s10 offen offset:0 sc1
  buffer_load_dwordx4 v[164:167], v4, s[36:39], s10 offen offset:1024 sc1
  buffer_load_dwordx4 v[168:171], v4, s[36:39], s10 offen offset:2048 sc1
  buffer_load_dwordx4 v[172:175], v4, s[36:39], s10 offen offset:3072 sc1
  buffer_load_dwordx4 v[176:179], v4, s[36:39], s11 offen offset:0 sc1
  buffer_load_dwordx4 v[180:183], v4, s[36:39], s11 offen offset:1024 sc1
  s_waitcnt vmcnt(7)
  v_max3_u32 v10, v152, v153, v154
  v_max_u32 v10, v10, v155
  v_cmp_eq_u32 vcc, -1, v10
  s_nop 0
  s_cbranch_vccnz L_oretry6
  s_branch L_ogo6
L_oretry7:
  s_sub_u32 s61, s61, 1
  s_cmp_gt_i32 s61, 0
  s_cbranch_scc0 L_ogo7
  s_waitcnt vmcnt(0)
  buffer_load_dwordx4 v[156:159], v4, s[36:39], s9 offen offset:3072 sc1
  buffer_load_dwordx4 v[160:163], v4, s[36:39], s10 offen offset:0 sc1
  buffer_load_dwordx4 v[164:167], v4, s[36:39], s10 offen offset:1024 sc1
  buffer_load_dwordx4 v[168:171], v4, s[36:39], s10 offen offset:2048 sc1
  buffer_load_dwordx4 v[172:175], v4, s[36:39], s10 offen offset:3072 sc1
  buffer_load_dwordx4 v[176:179], v4, s[36:39], s11 offen offset:0 sc1
  buffer_load_dwordx4 v[180:183], v4, s[36:39], s11 offen offset:1024 sc1
  buffer_load_dwordx4 v[184:187], v4, s[36:39], s11 offen offset:2048 sc1
  s_waitcnt vmcnt(7)
  v_max3_u32 v10, v156, v157, v158
  v_max_u32 v10, v10, v159
  v_cmp_eq_u32 vcc, -1, v10
  s_nop 0
  s_cbranch_vccnz L_oretry7
  s_branch L_ogo7
L_oretry8:
  s_sub_u32 s61, s61, 1
  s_cmp_gt_i32 s61, 0
  s_cbranch_scc0 L_ogo8
  s_waitcnt vmcnt(0)
  buffer_load_dwordx4 v[160:163], v4, s[36:39], s10 offen offset:0 sc1
  buffer_load_dwordx4 v[164:167], v4, s[36:39], s10 offen offset:1024 sc1
  buffer_load_dwordx4 v[168:171], v4, s[36:39], s10 offen offset:2048 sc1
  buffer_load_dwordx4 v[172:175], v4, s[36:39], s10 offen offset:3072 sc1
  buffer_load_dwordx4 v[176:179], v4, s[36:39], s11 offen offset:0 sc1
  buffer_load_dwordx4 v[180:183], v4, s[36:39], s11 offen offset:1024 sc1
  buffer_load_dwordx4 v[184:187], v4, s[36:39], s11 offen offset:2048 sc1
  buffer_load_dwordx4 v[188:191], v4, s[36:39], s11 offen offset:3072 sc1
  s_waitcnt vmcnt(7)
  v_max3_u32 v10, v160, v161, v162
  v_max_u32 v10, v10, v163
  v_cmp_eq_u32 vcc, -1, v10
  s_nop 0
  s_cbranch_vccnz L_oretry8
  s_branch L_ogo8
L_oretry9:
  s_sub_u32 s61, s61, 1
  s_cmp_gt_i32 s61, 0
  s_cbranch_scc0 L_ogo9
  s_waitcnt vmcnt(0)
  buffer_load_dwordx4 v[164:167], v4, s[36:39], s10 offen offset:1024 sc1
  buffer_load_dwordx4 v[168:171], v4, s[36:39], s10 offen offset:2048 sc1
  buffer_load_dwordx4 v[172:175], v4, s[36:39], s10 offen offset:3072 sc1
  buffer_load_dwordx4 v[176:179], v4, s[36:39], s11 offen offset:0 sc1
  buffer_load_dwordx4 v[180:183], v4, s[36:39], s11 offen offset:1024 sc1
  buffer_load_dwordx4 v[184:187], v4, s[36:39], s11 offen offset:2048 sc1
  buffer_load_dwordx4 v[188:191], v4, s[36:39], s11 offen offset:3072 sc1
  buffer_load_dwordx4 v[128:131], v4, s[36:39], s12 offen offset:0 sc1
  s_waitcnt vmcnt(7)
  v_max3_u32 v10, v164, v165, v166
  v_max_u32 v10, v10, v167
  v_cmp_eq_u32 vcc, -1, v10
  s_nop 0
  s_cbranch_vccnz L_oretry9
  s_branch L_ogo9
L_oretry10:
  s_sub_u32 s61, s61, 1
  s_cmp_gt_i32 s61, 0
  s_cbranch_scc0 L_ogo10
  s_waitcnt vmcnt(0)
  buffer_load_dwordx4 v[168:171], v4, s[36:39], s10 offen offset:2048 sc1
  buffer_load_dwordx4 v[172:175], v4, s[36:39], s10 offen offset:3072 sc1
  buffer_load_dwordx4 v[176:179], v4, s[36:39], s11 offen offset:0 sc1
  buffer_load_dwordx4 v[180:183], v4, s[36:39], s11 offen offset:1024 sc1
  buffer_load_dwordx4 v[184:187], v4, s[36:39], s11 offen offset:2048 sc1
  buffer_load_dwordx4 v[188:191], v4, s[36:39], s11 offen offset:3072 sc1
  buffer_load_dwordx4 v[128:131], v4, s[36:39], s12 offen offset:0 sc1
  buffer_load_dwordx4 v[132:135], v4, s[36:39], s12 offen offset:1024 sc1
  s_waitcnt vmcnt(7)
  v_max3_u32 v10, v168, v169, v170
  v_max_u32 v10, v10, v171
  v_cmp_eq_u32 vcc, -1, v10
  s_nop 0
  s_cbranch_vccnz L_oretry10
  s_branch L_ogo10
L_oretry11:
  s_sub_u32 s61, s61, 1
  s_cmp_gt_i32 s61, 0
  s_cbranch_scc0 L_ogo11
  s_waitcnt vmcnt(0)
  buffer_load_dwordx4 v[172:175], v4, s[36:39], s10 offen offset:3072 sc1
  buffer_load_dwordx4 v[176:179], v4, s[36:39], s11 offen offset:0 sc1
  buffer_load_dwordx4 v[180:183], v4, s[36:39], s11 offen offset:1024 sc1
  buffer_load_dwordx4 v[184:187], v4, s[36:39], s11 offen offset:2048 sc1
  buffer_load_dwordx4 v[188:191], v4, s[36:39], s11 offen offset:3072 sc1
  buffer_load_dwordx4 v[128:131], v4, s[36:39], s12 offen offset:0 sc1
  buffer_load_dwordx4 v[132:135], v4, s[36:39], s12 offen offset:1024 sc1
  buffer_load_dwordx4 v[136:139], v4, s[36:39], s12 offen offset:2048 sc1
  s_waitcnt vmcnt(7)
  v_max3_u32 v10, v172, v173, v174
  v_max_u32 v10, v10, v175
  v_cmp_eq_u32 vcc, -1, v10
  s_nop 0
  s_cbranch_vccnz L_oretry11
  s_branch L_ogo11
L_oretry12:
  s_sub_u32 s61, s61, 1
  s_cmp_gt_i32 s61, 0
  s_cbranch_scc0 L_ogo12
  s_waitcnt vmcnt(0)
  buffer_load_dwordx4 v[176:179], v4, s[36:39], s11 offen offset:0 sc1
  buffer_load_dwordx4 v[180:183], v4, s[36:39], s11 offen offset:1024 sc1
  buffer_load_dwordx4 v[184:187], v4, s[36:39], s11 offen offset:2048 sc1
  buffer_load_dwordx4 v[188:191], v4, s[36:39], s11 offen offset:3072 sc1
  buffer_load_dwordx4 v[128:131], v4, s[36:39], s12 offen offset:0 sc1
  buffer_load_dwordx4 v[132:135], v4, s[36:39], s12 offen offset:1024 sc1
  buffer_load_dwordx4 v[136:139], v4, s[36:39], s12 offen offset:2048 sc1
  buffer_load_dwordx4 v[140:143], v4, s[36:39], s12 offen offset:3072 sc1
  s_waitcnt vmcnt(7)
  v_max3_u32 v10, v176, v177, v178
  v_max_u32 v10, v10, v179
  v_cmp_eq_u32 vcc, -1, v10
  s_nop 0
  s_cbranch_vccnz L_oretry12
  s_branch L_ogo12
L_oretry13:
  s_sub_u32 s61, s61, 1
  s_cmp_gt_i32 s61, 0
  s_cbranch_scc0 L_ogo13
  s_waitcnt vmcnt(0)
  buffer_load_dwordx4 v[180:183], v4, s[36:39], s11 offen offset:1024 sc1
  buffer_load_dwordx4 v[184:187], v4, s[36:39], s11 offen offset:2048 sc1
  buffer_load_dwordx4 v[188:191], v4, s[36:39], s11 offen offset:3072 sc1
  buffer_load_dwordx4 v[128:131], v4, s[36:39], s12 offen offset:0 sc1
  buffer_load_dwordx4 v[132:135], v4, s[36:39], s12 offen offset:1024 sc1
  buffer_load_dwordx4 v[136:139], v4, s[36:39], s12 offen offset:2048 sc1
  buffer_load_dwordx4 v[140:143], v4, s[36:39], s12 offen offset:3072 sc1
  buffer_load_dwordx4 v[144:147], v4, s[36:39], s13 offen offset:0 sc1
  s_waitcnt vmcnt(7)
  v_max3_u32 v10, v180, v181, v182
  v_max_u32 v10, v10, v183
  v_cmp_eq_u32 vcc, -1, v10
  s_nop 0
  s_cbranch_vccnz L_oretry13
  s_branch L_ogo13
L_oretry14:
  s_sub_u32 s61, s61, 1
  s_cmp_gt_i32 s61, 0
  s_cbranch_scc0 L_ogo14
  s_waitcnt vmcnt(0)
  buffer_load_dwordx4 v[184:187], v4, s[36:39], s11 offen offset:2048 sc1
  buffer_load_dwordx4 v[188:191], v4, s[36:39], s11 offen offset:3072 sc1
  buffer_load_dwordx4 v[128:131], v4, s[36:39], s12 offen offset:0 sc1
  buffer_load_dwordx4 v[132:135], v4, s[36:39], s12 offen offset:1024 sc1
  buffer_load_dwordx4 v[136:139], v4, s[36:39], s12 offen offset:2048 sc1
  buffer_load_dwordx4 v[140:143], v4, s[36:39], s12 offen offset:3072 sc1
  buffer_load_dwordx4 v[144:147], v4, s[36:39], s13 offen offset:0 sc1
  buffer_load_dwordx4 v[148:151], v4, s[36:39], s13 offen offset:1024 sc1
  s_waitcnt vmcnt(7)
  v_max3_u32 v10, v184, v185, v186
  v_max_u32 v10, v10, v187
  v_cmp_eq_u32 vcc, -1, v10
  s_nop 0
  s_cbranch_vccnz L_oretry14
  s_branch L_ogo14
L_oretry15:
  s_sub_u32 s61, s61, 1
  s_cmp_gt_i32 s61, 0
  s_cbranch_scc0 L_ogo15
  s_waitcnt vmcnt(0)
  buffer_load_dwordx4 v[188:191], v4, s[36:39], s11 offen offset:3072 sc1
  buffer_load_dwordx4 v[128:131], v4, s[36:39], s12 offen offset:0 sc1
  buffer_load_dwordx4 v[132:135], v4, s[36:39], s12 offen offset:1024 sc1
  buffer_load_dwordx4 v[136:139], v4, s[36:39], s12 offen offset:2048 sc1
  buffer_load_dwordx4 v[140:143], v4, s[36:39], s12 offen offset:3072 sc1
  buffer_load_dwordx4 v[144:147], v4, s[36:39], s13 offen offset:0 sc1
  buffer_load_dwordx4 v[148:151], v4, s[36:39], s13 offen offset:1024 sc1
  buffer_load_dwordx4 v[152:155], v4, s[36:39], s13 offen offset:2048 sc1
  s_waitcnt vmcnt(7)
  v_max3_u32 v10, v188, v189, v190
  v_max_u32 v10, v10, v191
  v_cmp_eq_u32 vcc, -1, v10
  s_nop 0
  s_cbranch_vccnz L_oretry15
  s_branch L_ogo15
L_oretry16:
  s_sub_u32 s61, s61, 1
  s_cmp_gt_i32 s61, 0
  s_cbranch_scc0 L_ogo16
  s_waitcnt vmcnt(0)
  buffer_load_dwordx4 v[128:131], v4, s[36:39], s12 offen offset:0 sc1
  buffer_load_dwordx4 v[132:135], v4, s[36:39], s12 offen offset:1024 sc1
  buffer_load_dwordx4 v[136:139], v4, s[36:39], s12 offen offset:2048 sc1
  buffer_load_dwordx4 v[140:143], v4, s[36:39], s12 offen offset:3072 sc1
  buffer_load_dwordx4 v[144:147], v4, s[36:39], s13 offen offset:0 sc1
  buffer_load_dwordx4 v[148:151], v4, s[36:39], s13 offen offset:1024 sc1
  buffer_load_dwordx4 v[152:155], v4, s[36:39], s13 offen offset:2048 sc1
  buffer_load_dwordx4 v[156:159], v4, s[36:39], s13 offen offset:3072 sc1
  s_waitcnt vmcnt(7)
  v_max3_u32 v10, v128, v129, v130
  v_max_u32 v10, v10, v131
  v_cmp_eq_u32 vcc, -1, v10
  s_nop 0
  s_cbranch_vccnz L_oretry16
  s_branch L_ogo16
L_oretry17:
  s_sub_u32 s61, s61, 1
  s_cmp_gt_i32 s61, 0
  s_cbranch_scc0 L_ogo17
  s_waitcnt vmcnt(0)
  buffer_load_dwordx4 v[132:135], v4, s[36:39], s12 offen offset:1024 sc1
  buffer_load_dwordx4 v[136:139], v4, s[36:39], s12 offen offset:2048 sc1
  buffer_load_dwordx4 v[140:143], v4, s[36:39], s12 offen offset:3072 sc1
  buffer_load_dwordx4 v[144:147], v4, s[36:39], s13 offen offset:0 sc1
  buffer_load_dwordx4 v[148:151], v4, s[36:39], s13 offen offset:1024 sc1
  buffer_load_dwordx4 v[152:155], v4, s[36:39], s13 offen offset:2048 sc1
  buffer_load_dwordx4 v[156:159], v4, s[36:39], s13 offen offset:3072 sc1
  buffer_load_dwordx4 v[160:163], v4, s[36:39], s14 offen offset:0 sc1
  s_waitcnt vmcnt(7)
  v_max3_u32 v10, v132, v133, v134
  v_max_u32 v10, v10, v135
  v_cmp_eq_u32 vcc, -1, v10
  s_nop 0
  s_cbranch_vccnz L_oretry17
  s_branch L_ogo17
L_oretry18:
  s_sub_u32 s61, s61, 1
  s_cmp_gt_i32 s61, 0
  s_cbranch_scc0 L_ogo18
  s_waitcnt vmcnt(0)
  buffer_load_dwordx4 v[136:139], v4, s[36:39], s12 offen offset:2048 sc1
  buffer_load_dwordx4 v[140:143], v4, s[36:39], s12 offen offset:3072 sc1
  buffer_load_dwordx4 v[144:147], v4, s[36:39], s13 offen offset:0 sc1
  buffer_load_dwordx4 v[148:151], v4, s[36:39], s13 offen offset:1024 sc1
  buffer_load_dwordx4 v[152:155], v4, s[36:39], s13 offen offset:2048 sc1
  buffer_load_dwordx4 v[156:159], v4, s[36:39], s13 offen offset:3072 sc1
  buffer_load_dwordx4 v[160:163], v4, s[36:39], s14 offen offset:0 sc1
  buffer_load_dwordx4 v[164:167], v4, s[36:39], s14 offen offset:1024 sc1
  s_waitcnt vmcnt(7)
  v_max3_u32 v10, v136, v137, v138
  v_max_u32 v10, v10, v139
  v_cmp_eq_u32 vcc, -1, v10
  s_nop 0
  s_cbranch_vccnz L_oretry18
  s_branch L_ogo18
L_oretry19:
  s_sub_u32 s61, s61, 1
  s_cmp_gt_i32 s61, 0
  s_cbranch_scc0 L_ogo19
  s_waitcnt vmcnt(0)
  buffer_load_dwordx4 v[140:143], v4, s[36:39], s12 offen offset:3072 sc1
  buffer_load_dwordx4 v[144:147], v4, s[36:39], s13 offen offset:0 sc1
  buffer_load_dwordx4 v[148:151], v4, s[36:39], s13 offen offset:1024 sc1
  buffer_load_dwordx4 v[152:155], v4, s[36:39], s13 offen offset:2048 sc1
  buffer_load_dwordx4 v[156:159], v4, s[36:39], s13 offen offset:3072 sc1
  buffer_load_dwordx4 v[160:163], v4, s[36:39], s14 offen offset:0 sc1
  buffer_load_dwordx4 v[164:167], v4, s[36:39], s14 offen offset:1024 sc1
  buffer_load_dwordx4 v[168:171], v4, s[36:39], s14 offen offset:2048 sc1
  s_waitcnt vmcnt(7)
  v_max3_u32 v10, v140, v141, v142
  v_max_u32 v10, v10, v143
  v_cmp_eq_u32 vcc, -1, v10
  s_nop 0
  s_cbranch_vccnz L_oretry19
  s_branch L_ogo19
L_oretry20:
  s_sub_u32 s61, s61, 1
  s_cmp_gt_i32 s61, 0
  s_cbranch_scc0 L_ogo20
  s_waitcnt vmcnt(0)
  buffer_load_dwordx4 v[144:147], v4, s[36:39], s13 offen offset:0 sc1
  buffer_load_dwordx4 v[148:151], v4, s[36:39], s13 offen offset:1024 sc1
  buffer_load_dwordx4 v[152:155], v4, s[36:39], s13 offen offset:2048 sc1
  buffer_load_dwordx4 v[156:159], v4, s[36:39], s13 offen offset:3072 sc1
  buffer_load_dwordx4 v[160:163], v4, s[36:39], s14 offen offset:0 sc1
  buffer_load_dwordx4 v[164:167], v4, s[36:39], s14 offen offset:1024 sc1
  buffer_load_dwordx4 v[168:171], v4, s[36:39], s14 offen offset:2048 sc1
  buffer_load_dwordx4 v[172:175], v4, s[36:39], s14 offen offset:3072 sc1
  s_waitcnt vmcnt(7)
  v_max3_u32 v10, v144, v145, v146
  v_max_u32 v10, v10, v147
  v_cmp_eq_u32 vcc, -1, v10
  s_nop 0
  s_cbranch_vccnz L_oretry20
  s_branch L_ogo20
L_oretry21:
  s_sub_u32 s61, s61, 1
  s_cmp_gt_i32 s61, 0
  s_cbranch_scc0 L_ogo21
  s_waitcnt vmcnt(0)
  buffer_load_dwordx4 v[148:151], v4, s[36:39], s13 offen offset:1024 sc1
  buffer_load_dwordx4 v[152:155], v4, s[36:39], s13 offen offset:2048 sc1
  buffer_load_dwordx4 v[156:159], v4, s[36:39], s13 offen offset:3072 sc1
  buffer_load_dwordx4 v[160:163], v4, s[36:39], s14 offen offset:0 sc1
  buffer_load_dwordx4 v[164:167], v4, s[36:39], s14 offen offset:1024 sc1
  buffer_load_dwordx4 v[168:171], v4, s[36:39], s14 offen offset:2048 sc1
  buffer_load_dwordx4 v[172:175], v4, s[36:39], s14 offen offset:3072 sc1
  buffer_load_dwordx4 v[176:179], v4, s[36:39], s15 offen offset:0 sc1
  s_waitcnt vmcnt(7)
  v_max3_u32 v10, v148, v149, v150
  v_max_u32 v10, v10, v151
  v_cmp_eq_u32 vcc, -1, v10
  s_nop 0
  s_cbranch_vccnz L_oretry21
  s_branch L_ogo21
L_oretry22:
  s_sub_u32 s61, s61, 1
  s_cmp_gt_i32 s61, 0
  s_cbranch_scc0 L_ogo22
  s_waitcnt vmcnt(0)
  buffer_load_dwordx4 v[152:155], v4, s[36:39], s13 offen offset:2048 sc1
  buffer_load_dwordx4 v[156:159], v4, s[36:39], s13 offen offset:3072 sc1
  buffer_load_dwordx4 v[160:163], v4, s[36:39], s14 offen offset:0 sc1
  buffer_load_dwordx4 v[164:167], v4, s[36:39], s14 offen offset:1024 sc1
  buffer_load_dwordx4 v[168:171], v4, s[36:39], s14 offen offset:2048 sc1
  buffer_load_dwordx4 v[172:175], v4, s[36:39], s14 offen offset:3072 sc1
  buffer_load_dwordx4 v[176:179], v4, s[36:39], s15 offen offset:0 sc1
  buffer_load_dwordx4 v[180:183], v4, s[36:39], s15 offen offset:1024 sc1
  s_waitcnt vmcnt(7)
  v_max3_u32 v10, v152, v153, v154
  v_max_u32 v10, v10, v155
  v_cmp_eq_u32 vcc, -1, v10
  s_nop 0
  s_cbranch_vccnz L_oretry22
  s_branch L_ogo22
L_oretry23:
  s_sub_u32 s61, s61, 1
  s_cmp_gt_i32 s61, 0
  s_cbranch_scc0 L_ogo23
  s_waitcnt vmcnt(0)
  buffer_load_dwordx4 v[156:159], v4, s[36:39], s13 offen offset:3072 sc1
  buffer_load_dwordx4 v[160:163], v4, s[36:39], s14 offen offset:0 sc1
  buffer_load_dwordx4 v[164:167], v4, s[36:39], s14 offen offset:1024 sc1
  buffer_load_dwordx4 v[168:171], v4, s[36:39], s14 offen offset:2048 sc1
  buffer_load_dwordx4 v[172:175], v4, s[36:39], s14 offen offset:3072 sc1
  buffer_load_dwordx4 v[176:179], v4, s[36:39], s15 offen offset:0 sc1
  buffer_load_dwordx4 v[180:183], v4, s[36:39], s15 offen offset:1024 sc1
  buffer_load_dwordx4 v[184:187], v4, s[36:39], s15 offen offset:2048 sc1
  s_waitcnt vmcnt(7)
  v_max3_u32 v10, v156, v157, v158
  v_max_u32 v10, v10, v159
  v_cmp_eq_u32 vcc, -1, v10
  s_nop 0
  s_cbranch_vccnz L_oretry23
  s_branch L_ogo23
L_oretry24:
  s_sub_u32 s61, s61, 1
  s_cmp_gt_i32 s61, 0
  s_cbranch_scc0 L_ogo24
  s_waitcnt vmcnt(0)
  buffer_load_dwordx4 v[160:163], v4, s[36:39], s14 offen offset:0 sc1
  buffer_load_dwordx4 v[164:167], v4, s[36:39], s14 offen offset:1024 sc1
  buffer_load_dwordx4 v[168:171], v4, s[36:39], s14 offen offset:2048 sc1
  buffer_load_dwordx4 v[172:175], v4, s[36:39], s14 offen offset:3072 sc1
  buffer_load_dwordx4 v[176:179], v4, s[36:39], s15 offen offset:0 sc1
  buffer_load_dwordx4 v[180:183], v4, s[36:39], s15 offen offset:1024 sc1
  buffer_load_dwordx4 v[184:187], v4, s[36:39], s15 offen offset:2048 sc1
  buffer_load_dwordx4 v[188:191], v4, s[36:39], s15 offen offset:3072 sc1
  s_waitcnt vmcnt(7)
  v_max3_u32 v10, v160, v161, v162
  v_max_u32 v10, v10, v163
  v_cmp_eq_u32 vcc, -1, v10
  s_nop 0
  s_cbranch_vccnz L_oretry24
  s_branch L_ogo24
L_oretry25:
  s_sub_u32 s61, s61, 1
  s_cmp_gt_i32 s61, 0
  s_cbranch_scc0 L_ogo25
  s_waitcnt vmcnt(0)
  buffer_load_dwordx4 v[164:167], v4, s[36:39], s14 offen offset:1024 sc1
  buffer_load_dwordx4 v[168:171], v4, s[36:39], s14 offen offset:2048 sc1
  buffer_load_dwordx4 v[172:175], v4, s[36:39], s14 offen offset:3072 sc1
  buffer_load_dwordx4 v[176:179], v4, s[36:39], s15 offen offset:0 sc1
  buffer_load_dwordx4 v[180:183], v4, s[36:39], s15 offen offset:1024 sc1
  buffer_load_dwordx4 v[184:187], v4, s[36:39], s15 offen offset:2048 sc1
  buffer_load_dwordx4 v[188:191], v4, s[36:39], s15 offen offset:3072 sc1
  s_waitcnt vmcnt(6)
  v_max3_u32 v10, v164, v165, v166
  v_max_u32 v10, v10, v167
  v_cmp_eq_u32 vcc, -1, v10
  s_nop 0
  s_cbranch_vccnz L_oretry25
  s_branch L_ogo25
L_oretry26:
  s_sub_u32 s61, s61, 1
  s_cmp_gt_i32 s61, 0
  s_cbranch_scc0 L_ogo26
  s_waitcnt vmcnt(0)
  buffer_load_dwordx4 v[168:171], v4, s[36:39], s14 offen offset:2048 sc1
  buffer_load_dwordx4 v[172:175], v4, s[36:39], s14 offen offset:3072 sc1
  buffer_load_dwordx4 v[176:179], v4, s[36:39], s15 offen offset:0 sc1
  buffer_load_dwordx4 v[180:183], v4, s[36:39], s15 offen offset:1024 sc1
  buffer_load_dwordx4 v[184:187], v4, s[36:39], s15 offen offset:2048 sc1
  buffer_load_dwordx4 v[188:191], v4, s[36:39], s15 offen offset:3072 sc1
  s_waitcnt vmcnt(5)
  v_max3_u32 v10, v168, v169, v170
  v_max_u32 v10, v10, v171
  v_cmp_eq_u32 vcc, -1, v10
  s_nop 0
  s_cbranch_vccnz L_oretry26
  s_branch L_ogo26
L_oretry27:
  s_sub_u32 s61, s61, 1
  s_cmp_gt_i32 s61, 0
  s_cbranch_scc0 L_ogo27
  s_waitcnt vmcnt(0)
  buffer_load_dwordx4 v[172:175], v4, s[36:39], s14 offen offset:3072 sc1
  buffer_load_dwordx4 v[176:179], v4, s[36:39], s15 offen offset:0 sc1
  buffer_load_dwordx4 v[180:183], v4, s[36:39], s15 offen offset:1024 sc1
  buffer_load_dwordx4 v[184:187], v4, s[36:39], s15 offen offset:2048 sc1
  buffer_load_dwordx4 v[188:191], v4, s[36:39], s15 offen offset:3072 sc1
  s_waitcnt vmcnt(4)
  v_max3_u32 v10, v172, v173, v174
  v_max_u32 v10, v10, v175
  v_cmp_eq_u32 vcc, -1, v10
  s_nop 0
  s_cbranch_vccnz L_oretry27
  s_branch L_ogo27
L_oretry28:
  s_sub_u32 s61, s61, 1
  s_cmp_gt_i32 s61, 0
  s_cbranch_scc0 L_ogo28
  s_waitcnt vmcnt(0)
  buffer_load_dwordx4 v[176:179], v4, s[36:39], s15 offen offset:0 sc1
  buffer_load_dwordx4 v[180:183], v4, s[36:39], s15 offen offset:1024 sc1
  buffer_load_dwordx4 v[184:187], v4, s[36:39], s15 offen offset:2048 sc1
  buffer_load_dwordx4 v[188:191], v4, s[36:39], s15 offen offset:3072 sc1
  s_waitcnt vmcnt(3)
  v_max3_u32 v10, v176, v177, v178
  v_max_u32 v10, v10, v179
  v_cmp_eq_u32 vcc, -1, v10
  s_nop 0
  s_cbranch_vccnz L_oretry28
  s_branch L_ogo28
L_oretry29:
  s_sub_u32 s61, s61, 1
  s_cmp_gt_i32 s61, 0
  s_cbranch_scc0 L_ogo29
  s_waitcnt vmcnt(0)
  buffer_load_dwordx4 v[180:183], v4, s[36:39], s15 offen offset:1024 sc1
  buffer_load_dwordx4 v[184:187], v4, s[36:39], s15 offen offset:2048 sc1
  buffer_load_dwordx4 v[188:191], v4, s[36:39], s15 offen offset:3072 sc1
  s_waitcnt vmcnt(2)
  v_max3_u32 v10, v180, v181, v182
  v_max_u32 v10, v10, v183
  v_cmp_eq_u32 vcc, -1, v10
  s_nop 0
  s_cbranch_vccnz L_oretry29
  s_branch L_ogo29
L_oretry30:
  s_sub_u32 s61, s61, 1
  s_cmp_gt_i32 s61, 0
  s_cbranch_scc0 L_ogo30
  s_waitcnt vmcnt(0)
  buffer_load_dwordx4 v[184:187], v4, s[36:39], s15 offen offset:2048 sc1
  buffer_load_dwordx4 v[188:191], v4, s[36:39], s15 offen offset:3072 sc1
  s_waitcnt vmcnt(1)
  v_max3_u32 v10, v184, v185, v186
  v_max_u32 v10, v10, v187
  v_cmp_eq_u32 vcc, -1, v10
  s_nop 0
  s_cbranch_vccnz L_oretry30
  s_branch L_ogo30
L_oretry31:
  s_sub_u32 s61, s61, 1
  s_cmp_gt_i32 s61, 0
  s_cbranch_scc0 L_ogo31
  s_waitcnt vmcnt(0)
  buffer_load_dwordx4 v[188:191], v4, s[36:39], s15 offen offset:3072 sc1
  s_waitcnt vmcnt(0)
  v_max3_u32 v10, v188, v189, v190
  v_max_u32 v10, v10, v191
  v_cmp_eq_u32 vcc, -1, v10
  s_nop 0
  s_cbranch_vccnz L_oretry31
  s_branch L_ogo31
.section .rodata,"a"
.p2align 6
.amdhsa_kernel gated_mix__softmax_full_mha__mha_block__prompt_kernel
  .amdhsa_next_free_vgpr 256
  .amdhsa_next_free_sgpr 102
  .amdhsa_accum_offset 256
  .amdhsa_group_segment_fixed_size 0
  .amdhsa_kernarg_size 80
  .amdhsa_user_sgpr_count 2
  .amdhsa_user_sgpr_kernarg_segment_ptr 1
  .amdhsa_system_sgpr_workgroup_id_x 1
  .amdhsa_float_denorm_mode_32 3
.end_amdhsa_kernel
```
